```python
import torch

def _softmax(x, axis=-1):
    return torch.softmax(x, dim=axis)
def _gelu(x):
    return torch.nn.functional.gelu(x, approximate="tanh")
def _silu(x):
    return torch.nn.functional.silu(x)
def _sigmoid(x):
    return torch.sigmoid(x)
def _layernorm(x, axis=-1, eps=1e-5):
    m = x.mean(dim=axis, keepdim=True)
    v = x.var(dim=axis, keepdim=True, unbiased=False)
    return (x - m) / torch.sqrt(v + eps)
def _scatter_add(tgt, idx, src, axis=0):
    return tgt.clone().index_add_(axis, idx, src)
def _segment_sum(src, seg, n):
    out = torch.zeros((n,) + src.shape[1:], dtype=src.dtype)
    return out.index_add_(0, seg, src)
def _pad(x, pw):
    flat = tuple(v for pair in reversed(pw) for v in pair)
    return torch.nn.functional.pad(x, flat)

kernel_name = 'concat_heads__mha_block_cached__sliding_block_cached__decode'

def setup_inputs():

    _w = (lambda a: (lambda t: t.to(torch.bfloat16) if t.is_floating_point() else t)(torch.as_tensor(a)))
    def _A_setup():
        B, Sq, D = 1, 1, 512
        H, Sk, Dh = 32, 32768, 128
        return {
            "x": _w((lambda *s: torch.randn(*s, dtype=torch.bfloat16) * 0.8)(B, Sq, D)),
            "k_cache": _w((lambda *s: torch.randn(*s, dtype=torch.bfloat16) * 1.6)(B, H, Sk, Dh)),
            "v_cache": _w((lambda *s: torch.randn(*s, dtype=torch.bfloat16) * 0.2)(B, H, Sk, Dh)),
            "wq": _w((lambda *s: torch.randn(*s, dtype=torch.bfloat16) * 1.6)(D, H * Dh) * (D ** -0.5)),
            "wo": _w((lambda *s: torch.randn(*s, dtype=torch.bfloat16) * 0.2)(H * Dh, D) * ((H * Dh) ** -0.5)),
        }
    _A_in = _A_setup()

    def _B_setup():
        B, Sq, D = 1, 1, 512
        Hq, Hkv, Sk, Dh = 32, 8, 32768, 128
        assert Hq % Hkv == 0, (Hq, Hkv)
        return {
            "x": _w((lambda *s: torch.randn(*s, dtype=torch.bfloat16) * 0.8)(B, Sq, D)),
            "k_cache": _w((lambda *s: torch.randn(*s, dtype=torch.bfloat16) * 1.6)(B, Hkv, Sk, Dh)),
            "v_cache": _w((lambda *s: torch.randn(*s, dtype=torch.bfloat16) * 0.2)(B, Hkv, Sk, Dh)),
            "wq": _w((lambda *s: torch.randn(*s, dtype=torch.bfloat16) * 1.6)(D, Hq * Dh) * (D ** -0.5)),
            "wo": _w((lambda *s: torch.randn(*s, dtype=torch.bfloat16) * 0.2)(Hq * Dh, D) * ((Hq * Dh) ** -0.5)),
        }
    _B_in = _B_setup()

    return {
        "A_x": _A_in["x"],
        "A_k_cache": _A_in["k_cache"],
        "A_v_cache": _A_in["v_cache"],
        "A_wq": _A_in["wq"],
        "A_wo": _A_in["wo"],
        "B_x": _B_in["x"],
        "B_k_cache": _B_in["k_cache"],
        "B_v_cache": _B_in["v_cache"],
        "B_wq": _B_in["wq"],
        "B_wo": _B_in["wo"],
    }

def reference(A_x, A_k_cache, A_v_cache, A_wq, A_wo, B_x, B_k_cache, B_v_cache, B_wq, B_wo):
    def _A_ref(x, k_cache, v_cache, wq, wo):
        B, Sq, D = x.shape
        H, Dh = 32, 128
        q = (lambda x, *d: x.permute(*d))((x @ wq).reshape(B, Sq, H, Dh), 0, 2, 1, 3)
        scores = torch.einsum("bhqd,bhkd->bhqk", q, k_cache) * (Dh ** -0.5)
        p = _softmax(scores, axis=-1)
        o = torch.einsum("bhqk,bhkd->bhqd", p, v_cache)
        return (lambda x, *d: x.permute(*d))(o, 0, 2, 1, 3).reshape(B, Sq, H * Dh) @ wo

    def _B_ref(x, k_cache, v_cache, wq, wo):
        B, Sq, D = x.shape
        Hq, Dh = 32, 128
        Hkv, Sk = k_cache.shape[1], k_cache.shape[2]
        W = min(4096, max(256, Sk // 4))
        rep = Hq // Hkv
        q = (lambda x, *d: x.permute(*d))((x @ wq).reshape(B, Sq, Hq, Dh), 0, 2, 1, 3)
        k = (lambda x, n, axis: torch.repeat_interleave(x, n, dim=axis))(k_cache[:, :, Sk - W:, :], rep, axis=1)
        v = (lambda x, n, axis: torch.repeat_interleave(x, n, dim=axis))(v_cache[:, :, Sk - W:, :], rep, axis=1)
        scores = torch.einsum("bhqd,bhkd->bhqk", q, k) * (Dh ** -0.5)
        p = _softmax(scores, axis=-1)
        o = torch.einsum("bhqk,bhkd->bhqd", p, v)
        return (lambda x, *d: x.permute(*d))(o, 0, 2, 1, 3).reshape(B, Sq, Hq * Dh) @ wo

    a = _A_ref(A_x, A_k_cache, A_v_cache, A_wq, A_wo)
    b = _B_ref(B_x, B_k_cache, B_v_cache, B_wq, B_wo)
    return torch.concatenate([a, b], axis=-1)
```

```asm
; @launch grid=(288,1,1) block=(256,1,1) lds=28672
.amdgcn_target "amdgcn-amd-amdhsa--gfx950"
.text
.globl concat_heads__mha_block_cached__sliding_block_cached__decode_kernel
.p2align 8
.type concat_heads__mha_block_cached__sliding_block_cached__decode_kernel,@function
concat_heads__mha_block_cached__sliding_block_cached__decode_kernel:
    s_cmp_ge_u32 s2, 288
    s_cbranch_scc1 END
    s_load_dwordx16 s[24:39], s[0:1], 0
    s_load_dwordx8 s[40:47], s[0:1], 64
    s_load_dwordx2 s[48:49], s[0:1], 96
    v_lshrrev_b32 v13, 6, v0
    v_and_b32 v0, 63, v0
    v_readfirstlane_b32 s50, v13
    v_and_b32 v4, 15, v0
    v_lshrrev_b32 v5, 4, v0
    v_lshrrev_b32 v13, 2, v4
    v_lshlrev_b32 v1, 8, v13
    v_lshl_or_b32 v1, v5, 6, v1
    v_and_b32 v13, 3, v4
    v_lshl_or_b32 v1, v13, 4, v1
    v_lshlrev_b32 v2, 4, v0
    v_mov_b32 v13, 0x40000000
    v_cmp_eq_u32 vcc, 0, v0
    s_nop 1
    v_cndmask_b32 v3, v13, 0, vcc
    s_waitcnt lgkmcnt(0)
    s_mov_b32 s12, s48
    s_mov_b32 s13, s49
    s_mov_b32 s14, 0x400000
    s_mov_b32 s15, 0x00020000
    s_mov_b32 s20, s46
    s_mov_b32 s21, s47
    s_mov_b32 s22, 0x100
    s_mov_b32 s23, 0x00020000
    s_cmp_lg_u32 s2, 0
    s_cbranch_scc1 NO_NONCE_WRITE
    s_cmp_lg_u32 s50, 0
    s_cbranch_scc1 NO_NONCE_WRITE
    s_memrealtime s[70:71]
    s_waitcnt lgkmcnt(0)
    s_or_b32 s53, s70, 1
    v_mov_b32 v13, s53
    buffer_store_dword v13, v3, s[20:23], 0 offen sc1
NO_NONCE_WRITE:
    s_cmp_lt_u32 s2, 32
    s_cbranch_scc1 B_PATH
    s_sub_u32 s68, s2, 32
    s_lshr_b32 s51, s68, 3
    s_and_b32 s52, s68, 7
    s_lshl_b32 s53, s52, 2
    s_add_u32 s51, s51, s53
    s_and_b32 s51, s51, 31
    s_lshl_b32 s68, s51, 3
    s_add_u32 s68, s68, s52
    s_lshl_b32 s53, s51, 23
    s_add_u32 s4, s26, s53
    s_addc_u32 s5, s27, 0
    s_mov_b32 s6, 0x800000
    s_mov_b32 s7, 0x00020000
    s_add_u32 s8, s28, s53
    s_addc_u32 s9, s29, 0
    s_mov_b32 s10, 0x800000
    s_mov_b32 s11, 0x00020000
    s_lshl_b32 s53, s51, 8
    v_add_u32 v3, s53, v3
    s_add_u32 s96, s48, s53
    s_addc_u32 s97, s49, 0
    s_lshl_b32 s53, s52, 2
    s_add_u32 s53, s53, s50
    s_mov_b32 s100, s53
    s_mov_b32 s56, 0
    s_mul_i32 s3, s51, 0x0
    s_and_b32 s3, s51, 1
    s_cmp_lg_u32 s3, 0
    s_cselect_b32 s3, 0x600000, 0
    s_mov_b32 s16, s24
    s_mov_b32 s17, s25
    s_mov_b32 s18, 0x400
    s_mov_b32 s19, 0x00020000
    v_lshrrev_b32 v13, 2, v4
    v_lshlrev_b32 v13, 3, v13
    v_lshl_or_b32 v13, v5, 1, v13
    s_lshl_b32 s53, s52, 7
    s_lshl_b32 s54, s50, 5
    s_add_u32 s53, s53, s54
    buffer_load_ushort v21, v13, s[16:19], s53 offen
    v_lshlrev_b32 v14, 13, v5
    v_lshl_or_b32 v14, v4, 4, v14
    s_mov_b32 s16, s30
    s_mov_b32 s17, s31
    s_mov_b32 s18, 0x400000
    s_mov_b32 s19, 0x00020000
    s_lshl_b32 s53, s53, 12
    s_lshl_b32 s54, s51, 8
    s_add_u32 s53, s53, s54
    buffer_load_dwordx4 v[34:37], v14, s[16:19], s53 offen nt
    s_add_u32 s53, s53, 0x8000
    buffer_load_dwordx4 v[38:41], v14, s[16:19], s53 offen nt
    s_add_u32 s53, s53, 0x8000
    buffer_load_dwordx4 v[42:45], v14, s[16:19], s53 offen nt
    s_add_u32 s53, s53, 0x8000
    buffer_load_dwordx4 v[46:49], v14, s[16:19], s53 offen nt
    s_cmp_lg_u32 s50, 0
    s_cbranch_scc1 A_NONLEADER0
    v_mov_b32 v13, 0
    buffer_load_dword v20, v13, s[20:23], 0 offen sc1
    s_cmp_lg_u32 s52, 0
    s_cbranch_scc1 A_NOCTR
    v_mov_b32 v18, 16
    buffer_store_dword v18, v3, s[12:15], 0 offen sc1
A_NOCTR:
    s_branch A_COMMON0
A_NONLEADER0:
    s_mov_b32 s57, 0
    s_mov_b32 s72, 0
    s_mov_b32 s73, 0
    s_mov_b32 s99, 0
    s_mov_b32 s69, s100
    s_mov_b32 s75, 0
    s_mov_b32 s101, 0
    s_mov_b32 s76, 0
    s_cmp_lg_u32 s73, 0
    s_cbranch_scc1 IS_V0
    s_cmp_ge_u32 s99, 0x1000
    s_cbranch_scc1 IS_TOV0
    s_cmp_eq_u32 s76, 0
    s_cbranch_scc1 RN_Da0
    s_waitcnt lgkmcnt(0)
    s_min_u32 s69, s98, 0x10000
    s_add_u32 s69, s69, 816
    s_cmp_lt_u32 s56, 0x1000
    s_cselect_b32 s69, s69, 0x10000
    s_sub_u32 s101, s75, 1
    s_mov_b32 s75, 0
    s_mov_b32 s76, 0
RN_Da0:
    s_cmp_ge_u32 s69, 2048
    s_cbranch_scc1 IS_TOV0
    s_cmp_ge_u32 s69, 1824
    s_cselect_b32 s99, 0x1000, s99
    s_cbranch_scc1 IS_TOV0
    s_sub_u32 s53, s72, s57
    s_cmp_ge_u32 s53, 40
    s_cbranch_scc1 IS_VG0
IS_K0:
    s_lshl_b32 s74, s69, 12
    s_xor_b32 s74, s74, s3
    s_and_b32 s71, s72, 63
    s_mov_b32 m0, s71
    s_add_u32 s72, s72, 1
    s_mov_b32 s70, 1
    v_writelane_b32 v58, s74, m0
    s_add_u32 s56, s56, 1
    s_cmp_lt_u32 s56, 26
    s_cbranch_scc1 GN_ST0
    s_cmp_eq_u32 s101, 0
    s_cselect_b32 s76, 1, 0
    s_add_u32 s69, s69, s101
    s_mov_b32 s101, 0
    s_branch GN_L0
GN_ST0:
    s_add_u32 s69, s69, 32
    s_cmp_lt_u32 s56, 25
    s_cbranch_scc1 GN_D0
GN_L0:
    s_cmp_lg_u32 s75, 0
    s_cbranch_scc1 GN_D0
    s_cmp_lt_u32 s69, 1728
    s_cselect_b32 s75, 2, 1
    s_mov_b32 s98, s75
    s_atomic_add s98, s[96:97], 0x0 glc
GN_D0:
    s_branch IS_D0
IS_TOV0:
    s_mov_b32 s73, 1
IS_V0:
    s_cmp_lg_u32 s57, s72
    s_cbranch_scc1 IS_VG0
    s_mov_b32 s73, 0
    s_cmp_eq_u32 s76, 0
    s_cbranch_scc1 RN_Db0
    s_waitcnt lgkmcnt(0)
    s_min_u32 s69, s98, 0x10000
    s_add_u32 s69, s69, 816
    s_cmp_lt_u32 s56, 0x1000
    s_cselect_b32 s69, s69, 0x10000
    s_sub_u32 s101, s75, 1
    s_mov_b32 s75, 0
    s_mov_b32 s76, 0
RN_Db0:
    s_cmp_lt_u32 s69, 2048
    s_cbranch_scc1 IS_K0
    s_mov_b32 s73, 1
    s_mov_b32 s70, 0
    s_mov_b32 s74, 0x40000000
    s_branch IS_D0
IS_VG0:
    s_and_b32 s71, s57, 63
    v_readlane_b32 s74, v58, s71
    s_add_u32 s57, s57, 1
    s_mov_b32 s70, 2
    s_nop 2
IS_D0:
    s_cmp_eq_u32 s70, 1
    s_cbranch_scc1 FI_K1
    buffer_load_dwordx4 v[96:99], v2, s[8:11], s74 offen offset:0 nt
    buffer_load_dwordx4 v[100:103], v2, s[8:11], s74 offen offset:1024 nt
    buffer_load_dwordx4 v[104:107], v2, s[8:11], s74 offen offset:2048 nt
    buffer_load_dwordx4 v[108:111], v2, s[8:11], s74 offen offset:3072 nt
    s_branch FI_D1
FI_K1:
    buffer_load_dwordx4 v[96:99], v1, s[4:7], s74 offen offset:0 nt
    buffer_load_dwordx4 v[100:103], v1, s[4:7], s74 offen offset:1024 nt
    buffer_load_dwordx4 v[104:107], v1, s[4:7], s74 offen offset:2048 nt
    buffer_load_dwordx4 v[108:111], v1, s[4:7], s74 offen offset:3072 nt
FI_D1:
    s_mov_b32 s62, s70
    s_mov_b32 s66, s71
    s_cmp_lg_u32 s73, 0
    s_cbranch_scc1 IS_V2
    s_cmp_ge_u32 s99, 0x1000
    s_cbranch_scc1 IS_TOV2
    s_cmp_eq_u32 s76, 0
    s_cbranch_scc1 RN_Da2
    s_waitcnt lgkmcnt(0)
    s_min_u32 s69, s98, 0x10000
    s_add_u32 s69, s69, 816
    s_cmp_lt_u32 s56, 0x1000
    s_cselect_b32 s69, s69, 0x10000
    s_sub_u32 s101, s75, 1
    s_mov_b32 s75, 0
    s_mov_b32 s76, 0
RN_Da2:
    s_cmp_ge_u32 s69, 2048
    s_cbranch_scc1 IS_TOV2
    s_cmp_ge_u32 s69, 1824
    s_cselect_b32 s99, 0x1000, s99
    s_cbranch_scc1 IS_TOV2
    s_sub_u32 s53, s72, s57
    s_cmp_ge_u32 s53, 40
    s_cbranch_scc1 IS_VG2
IS_K2:
    s_lshl_b32 s74, s69, 12
    s_xor_b32 s74, s74, s3
    s_and_b32 s71, s72, 63
    s_mov_b32 m0, s71
    s_add_u32 s72, s72, 1
    s_mov_b32 s70, 1
    v_writelane_b32 v58, s74, m0
    s_add_u32 s56, s56, 1
    s_cmp_lt_u32 s56, 26
    s_cbranch_scc1 GN_ST2
    s_cmp_eq_u32 s101, 0
    s_cselect_b32 s76, 1, 0
    s_add_u32 s69, s69, s101
    s_mov_b32 s101, 0
    s_branch GN_L2
GN_ST2:
    s_add_u32 s69, s69, 32
    s_cmp_lt_u32 s56, 25
    s_cbranch_scc1 GN_D2
GN_L2:
    s_cmp_lg_u32 s75, 0
    s_cbranch_scc1 GN_D2
    s_cmp_lt_u32 s69, 1728
    s_cselect_b32 s75, 2, 1
    s_mov_b32 s98, s75
    s_atomic_add s98, s[96:97], 0x0 glc
GN_D2:
    s_branch IS_D2
IS_TOV2:
    s_mov_b32 s73, 1
IS_V2:
    s_cmp_lg_u32 s57, s72
    s_cbranch_scc1 IS_VG2
    s_mov_b32 s73, 0
    s_cmp_eq_u32 s76, 0
    s_cbranch_scc1 RN_Db2
    s_waitcnt lgkmcnt(0)
    s_min_u32 s69, s98, 0x10000
    s_add_u32 s69, s69, 816
    s_cmp_lt_u32 s56, 0x1000
    s_cselect_b32 s69, s69, 0x10000
    s_sub_u32 s101, s75, 1
    s_mov_b32 s75, 0
    s_mov_b32 s76, 0
RN_Db2:
    s_cmp_lt_u32 s69, 2048
    s_cbranch_scc1 IS_K2
    s_mov_b32 s73, 1
    s_mov_b32 s70, 0
    s_mov_b32 s74, 0x40000000
    s_branch IS_D2
IS_VG2:
    s_and_b32 s71, s57, 63
    v_readlane_b32 s74, v58, s71
    s_add_u32 s57, s57, 1
    s_mov_b32 s70, 2
    s_nop 2
IS_D2:
    s_cmp_eq_u32 s70, 1
    s_cbranch_scc1 FI_K3
    buffer_load_dwordx4 v[112:115], v2, s[8:11], s74 offen offset:0 nt
    buffer_load_dwordx4 v[116:119], v2, s[8:11], s74 offen offset:1024 nt
    buffer_load_dwordx4 v[120:123], v2, s[8:11], s74 offen offset:2048 nt
    buffer_load_dwordx4 v[124:127], v2, s[8:11], s74 offen offset:3072 nt
    s_branch FI_D3
FI_K3:
    buffer_load_dwordx4 v[112:115], v1, s[4:7], s74 offen offset:0 nt
    buffer_load_dwordx4 v[116:119], v1, s[4:7], s74 offen offset:1024 nt
    buffer_load_dwordx4 v[120:123], v1, s[4:7], s74 offen offset:2048 nt
    buffer_load_dwordx4 v[124:127], v1, s[4:7], s74 offen offset:3072 nt
FI_D3:
    s_mov_b32 s63, s70
    s_mov_b32 s67, s71
    v_mov_b32 v13, 0
    ds_write_b32 v13, v13 offset:1028
A_COMMON0:
    v_and_b32 v13, 1, v4
    v_cmp_eq_u32 vcc, 1, v13
    v_mov_b32 v14, 0xffff
    v_mov_b32 v15, 0xffff0000
    v_cndmask_b32 v14, v14, v15, vcc
    v_lshrrev_b32 v13, 1, v4
    v_cmp_eq_u32 vcc, 0, v13
    s_nop 1
    v_cndmask_b32 v6, 0, v14, vcc
    v_cmp_eq_u32 vcc, 1, v13
    s_nop 1
    v_cndmask_b32 v7, 0, v14, vcc
    v_cmp_eq_u32 vcc, 2, v13
    s_nop 1
    v_cndmask_b32 v8, 0, v14, vcc
    v_cmp_eq_u32 vcc, 3, v13
    s_nop 1
    v_cndmask_b32 v9, 0, v14, vcc
    s_mov_b32 s58, 0x3db504f3
    s_mov_b32 s59, 0x3fb8aa3b
    s_mov_b32 s76, 0
    s_mov_b32 s74, 0x01000100
    s_mov_b32 s75, 0x03020302
    v_mov_b32 v10, 0xff800000
    v_mov_b32 v11, 0xff800000
    v_mov_b32 v12, 0
    s_mov_b32 s75, 0
    s_mov_b32 s77, 0
    s_cmp_eq_u32 s50, 0
    s_cbranch_scc1 A_LW
    s_waitcnt vmcnt(8)
    s_branch A_QMFMA
A_LW:
    s_waitcnt vmcnt(1)
A_QMFMA:
    v_lshl_or_b32 v21, v21, 16, v21
    s_nop 1
    v_and_b32_dpp v22, v21, v6 row_newbcast:0 row_mask:0xf bank_mask:0xf
    v_and_b32_dpp v23, v21, v7 row_newbcast:0 row_mask:0xf bank_mask:0xf
    v_and_b32_dpp v24, v21, v8 row_newbcast:0 row_mask:0xf bank_mask:0xf
    v_and_b32_dpp v25, v21, v9 row_newbcast:0 row_mask:0xf bank_mask:0xf
    v_and_b32_dpp v26, v21, v6 row_newbcast:4 row_mask:0xf bank_mask:0xf
    v_and_b32_dpp v27, v21, v7 row_newbcast:4 row_mask:0xf bank_mask:0xf
    v_and_b32_dpp v28, v21, v8 row_newbcast:4 row_mask:0xf bank_mask:0xf
    v_and_b32_dpp v29, v21, v9 row_newbcast:4 row_mask:0xf bank_mask:0xf
    v_mfma_f32_16x16x32_bf16 v[54:57], v[22:25], v[34:37], 0
    v_and_b32_dpp v22, v21, v6 row_newbcast:8 row_mask:0xf bank_mask:0xf
    v_and_b32_dpp v23, v21, v7 row_newbcast:8 row_mask:0xf bank_mask:0xf
    v_and_b32_dpp v24, v21, v8 row_newbcast:8 row_mask:0xf bank_mask:0xf
    v_and_b32_dpp v25, v21, v9 row_newbcast:8 row_mask:0xf bank_mask:0xf
    v_mfma_f32_16x16x32_bf16 v[54:57], v[26:29], v[38:41], v[54:57]
    v_and_b32_dpp v26, v21, v6 row_newbcast:12 row_mask:0xf bank_mask:0xf
    v_and_b32_dpp v27, v21, v7 row_newbcast:12 row_mask:0xf bank_mask:0xf
    v_and_b32_dpp v28, v21, v8 row_newbcast:12 row_mask:0xf bank_mask:0xf
    v_and_b32_dpp v29, v21, v9 row_newbcast:12 row_mask:0xf bank_mask:0xf
    v_mfma_f32_16x16x32_bf16 v[54:57], v[22:25], v[42:45], v[54:57]
    s_nop 0
    v_mfma_f32_16x16x32_bf16 v[54:57], v[26:29], v[46:49], v[54:57]
    v_lshlrev_b32 v13, 5, v4
    v_lshl_or_b32 v13, v5, 4, v13
    s_lshl_b32 s53, s50, 9
    v_add_u32 v14, s53, v13
    s_cmp_eq_u32 s50, 0
    s_cbranch_scc1 A_LEADER1
    s_nop 2
    s_mov_b32 exec_hi, 0
    ds_write_b128 v14, v[54:57] offset:2048
    s_mov_b64 exec, -1
    s_waitcnt lgkmcnt(0)
    s_barrier
    s_branch A_PACE
A_LEADER1:
    s_barrier
    ds_read_b128 v[38:41], v13 offset:2560
    ds_read_b128 v[42:45], v13 offset:3072
    ds_read_b128 v[46:49], v13 offset:3584
NONCE_A:
    s_waitcnt vmcnt(0)
    v_readfirstlane_b32 s55, v20
    s_cmp_lg_u32 s55, 0
    s_cbranch_scc1 NONCE_OK_A
    s_add_u32 s76, s76, 1
    s_and_b32 s78, s76, 63
    s_cmp_lg_u32 s78, 63
    s_cbranch_scc1 SPINR0
    s_waitcnt vmcnt(0)
    buffer_inv sc1
    s_waitcnt vmcnt(0)
SPINR0:
    s_cmp_gt_u32 s76, 0x40000
    s_cbranch_scc1 NONCE_OK_A
    s_sleep 1
    v_mov_b32 v13, 0
    buffer_load_dword v20, v13, s[20:23], 0 offen sc1
    s_branch NONCE_A
NONCE_OK_A:
    s_waitcnt lgkmcnt(0)
    v_add_f32 v54, v54, v38
    v_add_f32 v55, v55, v39
    v_add_f32 v56, v56, v40
    v_add_f32 v57, v57, v41
    v_add_f32 v54, v54, v42
    v_add_f32 v55, v55, v43
    v_add_f32 v56, v56, v44
    v_add_f32 v57, v57, v45
    v_add_f32 v54, v54, v46
    v_add_f32 v55, v55, v47
    v_add_f32 v56, v56, v48
    v_add_f32 v57, v57, v49
    v_lshlrev_b32 v13, 6, v4
    v_lshl_or_b32 v13, v5, 5, v13
    v_mov_b32 v14, 0x40000000
    v_cmp_gt_u32 vcc, 32, v0
    s_lshl_b32 s53, s68, 10
    s_add_u32 s53, s53, 0x10000
    v_cndmask_b32 v13, v14, v13, vcc
    v_mov_b32 v64, v54
    v_mov_b32 v65, s55
    v_mov_b32 v66, v55
    v_mov_b32 v67, s55
    v_mov_b32 v68, v56
    v_mov_b32 v69, s55
    v_mov_b32 v70, v57
    v_mov_b32 v71, s55
    buffer_store_dwordx4 v[64:67], v13, s[12:15], s53 offen sc1
    buffer_store_dwordx4 v[68:71], v13, s[12:15], s53 offen offset:16 sc1
    v_and_b32 v13, 1, v5
    v_lshlrev_b32 v13, 5, v13
    v_lshl_or_b32 v13, v4, 6, v13
    v_lshrrev_b32 v14, 5, v0
    v_lshl_or_b32 v13, v14, 12, v13
    s_lshl_b32 s53, s51, 13
    s_add_u32 s53, s53, 0x10000
    buffer_load_dwordx4 v[72:75], v13, s[12:15], s53 offen offset:0 sc1
    buffer_load_dwordx4 v[76:79], v13, s[12:15], s53 offen offset:16 sc1
    buffer_load_dwordx4 v[80:83], v13, s[12:15], s53 offen offset:1024 sc1
    buffer_load_dwordx4 v[84:87], v13, s[12:15], s53 offen offset:1040 sc1
    buffer_load_dwordx4 v[88:91], v13, s[12:15], s53 offen offset:2048 sc1
    buffer_load_dwordx4 v[92:95], v13, s[12:15], s53 offen offset:2064 sc1
    buffer_load_dwordx4 v[96:99], v13, s[12:15], s53 offen offset:3072 sc1
    buffer_load_dwordx4 v[100:103], v13, s[12:15], s53 offen offset:3088 sc1
A_Q_POLL:
    s_waitcnt vmcnt(0)
    s_mov_b32 s69, 0
    v_cmp_ne_u32 vcc, s55, v73
    v_cmp_ne_u32 s[78:79], s55, v75
    s_or_b64 vcc, vcc, s[78:79]
    s_cbranch_vccz A_Q_S0
    s_mov_b64 exec, vcc
    buffer_load_dwordx4 v[72:75], v13, s[12:15], s53 offen offset:0 sc1
    s_mov_b64 exec, -1
    s_mov_b32 s69, 1
A_Q_S0:
    v_cmp_ne_u32 vcc, s55, v77
    v_cmp_ne_u32 s[78:79], s55, v79
    s_or_b64 vcc, vcc, s[78:79]
    s_cbranch_vccz A_Q_S1
    s_mov_b64 exec, vcc
    buffer_load_dwordx4 v[76:79], v13, s[12:15], s53 offen offset:16 sc1
    s_mov_b64 exec, -1
    s_mov_b32 s69, 1
A_Q_S1:
    v_cmp_ne_u32 vcc, s55, v81
    v_cmp_ne_u32 s[78:79], s55, v83
    s_or_b64 vcc, vcc, s[78:79]
    s_cbranch_vccz A_Q_S2
    s_mov_b64 exec, vcc
    buffer_load_dwordx4 v[80:83], v13, s[12:15], s53 offen offset:1024 sc1
    s_mov_b64 exec, -1
    s_mov_b32 s69, 1
A_Q_S2:
    v_cmp_ne_u32 vcc, s55, v85
    v_cmp_ne_u32 s[78:79], s55, v87
    s_or_b64 vcc, vcc, s[78:79]
    s_cbranch_vccz A_Q_S3
    s_mov_b64 exec, vcc
    buffer_load_dwordx4 v[84:87], v13, s[12:15], s53 offen offset:1040 sc1
    s_mov_b64 exec, -1
    s_mov_b32 s69, 1
A_Q_S3:
    v_cmp_ne_u32 vcc, s55, v89
    v_cmp_ne_u32 s[78:79], s55, v91
    s_or_b64 vcc, vcc, s[78:79]
    s_cbranch_vccz A_Q_S4
    s_mov_b64 exec, vcc
    buffer_load_dwordx4 v[88:91], v13, s[12:15], s53 offen offset:2048 sc1
    s_mov_b64 exec, -1
    s_mov_b32 s69, 1
A_Q_S4:
    v_cmp_ne_u32 vcc, s55, v93
    v_cmp_ne_u32 s[78:79], s55, v95
    s_or_b64 vcc, vcc, s[78:79]
    s_cbranch_vccz A_Q_S5
    s_mov_b64 exec, vcc
    buffer_load_dwordx4 v[92:95], v13, s[12:15], s53 offen offset:2064 sc1
    s_mov_b64 exec, -1
    s_mov_b32 s69, 1
A_Q_S5:
    v_cmp_ne_u32 vcc, s55, v97
    v_cmp_ne_u32 s[78:79], s55, v99
    s_or_b64 vcc, vcc, s[78:79]
    s_cbranch_vccz A_Q_S6
    s_mov_b64 exec, vcc
    buffer_load_dwordx4 v[96:99], v13, s[12:15], s53 offen offset:3072 sc1
    s_mov_b64 exec, -1
    s_mov_b32 s69, 1
A_Q_S6:
    v_cmp_ne_u32 vcc, s55, v101
    v_cmp_ne_u32 s[78:79], s55, v103
    s_or_b64 vcc, vcc, s[78:79]
    s_cbranch_vccz A_Q_S7
    s_mov_b64 exec, vcc
    buffer_load_dwordx4 v[100:103], v13, s[12:15], s53 offen offset:3088 sc1
    s_mov_b64 exec, -1
    s_mov_b32 s69, 1
A_Q_S7:
    s_cmp_eq_u32 s69, 0
    s_cbranch_scc1 A_Q_DONE
    s_add_u32 s76, s76, 1
    s_and_b32 s78, s76, 63
    s_cmp_lg_u32 s78, 63
    s_cbranch_scc1 SPINR1
    s_waitcnt vmcnt(0)
    buffer_inv sc1
    s_waitcnt vmcnt(0)
SPINR1:
    s_cmp_gt_u32 s76, 0x40000
    s_cbranch_scc1 A_Q_DONE
    s_sleep 1
    s_branch A_Q_POLL
A_Q_DONE:
    s_waitcnt vmcnt(0)
    v_add_f32 v54, v72, v80
    v_add_f32 v54, v54, v88
    v_add_f32 v54, v54, v96
    v_add_f32 v55, v74, v82
    v_add_f32 v55, v55, v90
    v_add_f32 v55, v55, v98
    v_add_f32 v56, v76, v84
    v_add_f32 v56, v56, v92
    v_add_f32 v56, v56, v100
    v_add_f32 v57, v78, v86
    v_add_f32 v57, v57, v94
    v_add_f32 v57, v57, v102
    s_mov_b32 s57, 0
    s_mov_b32 s72, 0
    s_mov_b32 s73, 0
    s_mov_b32 s99, 0
    s_mov_b32 s69, s100
    s_mov_b32 s75, 0
    s_mov_b32 s101, 0
    s_mov_b32 s76, 0
    s_cmp_lg_u32 s73, 0
    s_cbranch_scc1 IS_V4
    s_cmp_ge_u32 s99, 0x1000
    s_cbranch_scc1 IS_TOV4
    s_cmp_eq_u32 s76, 0
    s_cbranch_scc1 RN_Da4
    s_waitcnt lgkmcnt(0)
    s_min_u32 s69, s98, 0x10000
    s_add_u32 s69, s69, 816
    s_cmp_lt_u32 s56, 0x1000
    s_cselect_b32 s69, s69, 0x10000
    s_sub_u32 s101, s75, 1
    s_mov_b32 s75, 0
    s_mov_b32 s76, 0
RN_Da4:
    s_cmp_ge_u32 s69, 2048
    s_cbranch_scc1 IS_TOV4
    s_cmp_ge_u32 s69, 1824
    s_cselect_b32 s99, 0x1000, s99
    s_cbranch_scc1 IS_TOV4
    s_sub_u32 s53, s72, s57
    s_cmp_ge_u32 s53, 40
    s_cbranch_scc1 IS_VG4
IS_K4:
    s_lshl_b32 s74, s69, 12
    s_xor_b32 s74, s74, s3
    s_and_b32 s71, s72, 63
    s_mov_b32 m0, s71
    s_add_u32 s72, s72, 1
    s_mov_b32 s70, 1
    v_writelane_b32 v58, s74, m0
    s_add_u32 s56, s56, 1
    s_cmp_lt_u32 s56, 26
    s_cbranch_scc1 GN_ST4
    s_cmp_eq_u32 s101, 0
    s_cselect_b32 s76, 1, 0
    s_add_u32 s69, s69, s101
    s_mov_b32 s101, 0
    s_branch GN_L4
GN_ST4:
    s_add_u32 s69, s69, 32
    s_cmp_lt_u32 s56, 25
    s_cbranch_scc1 GN_D4
GN_L4:
    s_cmp_lg_u32 s75, 0
    s_cbranch_scc1 GN_D4
    s_cmp_lt_u32 s69, 1728
    s_cselect_b32 s75, 2, 1
    s_mov_b32 s98, s75
    s_atomic_add s98, s[96:97], 0x0 glc
GN_D4:
    s_branch IS_D4
IS_TOV4:
    s_mov_b32 s73, 1
IS_V4:
    s_cmp_lg_u32 s57, s72
    s_cbranch_scc1 IS_VG4
    s_mov_b32 s73, 0
    s_cmp_eq_u32 s76, 0
    s_cbranch_scc1 RN_Db4
    s_waitcnt lgkmcnt(0)
    s_min_u32 s69, s98, 0x10000
    s_add_u32 s69, s69, 816
    s_cmp_lt_u32 s56, 0x1000
    s_cselect_b32 s69, s69, 0x10000
    s_sub_u32 s101, s75, 1
    s_mov_b32 s75, 0
    s_mov_b32 s76, 0
RN_Db4:
    s_cmp_lt_u32 s69, 2048
    s_cbranch_scc1 IS_K4
    s_mov_b32 s73, 1
    s_mov_b32 s70, 0
    s_mov_b32 s74, 0x40000000
    s_branch IS_D4
IS_VG4:
    s_and_b32 s71, s57, 63
    v_readlane_b32 s74, v58, s71
    s_add_u32 s57, s57, 1
    s_mov_b32 s70, 2
    s_nop 2
IS_D4:
    s_cmp_eq_u32 s70, 1
    s_cbranch_scc1 FI_K5
    buffer_load_dwordx4 v[64:67], v2, s[8:11], s74 offen offset:0 nt
    buffer_load_dwordx4 v[68:71], v2, s[8:11], s74 offen offset:1024 nt
    buffer_load_dwordx4 v[72:75], v2, s[8:11], s74 offen offset:2048 nt
    buffer_load_dwordx4 v[76:79], v2, s[8:11], s74 offen offset:3072 nt
    s_branch FI_D5
FI_K5:
    buffer_load_dwordx4 v[64:67], v1, s[4:7], s74 offen offset:0 nt
    buffer_load_dwordx4 v[68:71], v1, s[4:7], s74 offen offset:1024 nt
    buffer_load_dwordx4 v[72:75], v1, s[4:7], s74 offen offset:2048 nt
    buffer_load_dwordx4 v[76:79], v1, s[4:7], s74 offen offset:3072 nt
FI_D5:
    s_mov_b32 s60, s70
    s_mov_b32 s64, s71
    s_cmp_lg_u32 s73, 0
    s_cbranch_scc1 IS_V6
    s_cmp_ge_u32 s99, 0x1000
    s_cbranch_scc1 IS_TOV6
    s_cmp_eq_u32 s76, 0
    s_cbranch_scc1 RN_Da6
    s_waitcnt lgkmcnt(0)
    s_min_u32 s69, s98, 0x10000
    s_add_u32 s69, s69, 816
    s_cmp_lt_u32 s56, 0x1000
    s_cselect_b32 s69, s69, 0x10000
    s_sub_u32 s101, s75, 1
    s_mov_b32 s75, 0
    s_mov_b32 s76, 0
RN_Da6:
    s_cmp_ge_u32 s69, 2048
    s_cbranch_scc1 IS_TOV6
    s_cmp_ge_u32 s69, 1824
    s_cselect_b32 s99, 0x1000, s99
    s_cbranch_scc1 IS_TOV6
    s_sub_u32 s53, s72, s57
    s_cmp_ge_u32 s53, 40
    s_cbranch_scc1 IS_VG6
IS_K6:
    s_lshl_b32 s74, s69, 12
    s_xor_b32 s74, s74, s3
    s_and_b32 s71, s72, 63
    s_mov_b32 m0, s71
    s_add_u32 s72, s72, 1
    s_mov_b32 s70, 1
    v_writelane_b32 v58, s74, m0
    s_add_u32 s56, s56, 1
    s_cmp_lt_u32 s56, 26
    s_cbranch_scc1 GN_ST6
    s_cmp_eq_u32 s101, 0
    s_cselect_b32 s76, 1, 0
    s_add_u32 s69, s69, s101
    s_mov_b32 s101, 0
    s_branch GN_L6
GN_ST6:
    s_add_u32 s69, s69, 32
    s_cmp_lt_u32 s56, 25
    s_cbranch_scc1 GN_D6
GN_L6:
    s_cmp_lg_u32 s75, 0
    s_cbranch_scc1 GN_D6
    s_cmp_lt_u32 s69, 1728
    s_cselect_b32 s75, 2, 1
    s_mov_b32 s98, s75
    s_atomic_add s98, s[96:97], 0x0 glc
GN_D6:
    s_branch IS_D6
IS_TOV6:
    s_mov_b32 s73, 1
IS_V6:
    s_cmp_lg_u32 s57, s72
    s_cbranch_scc1 IS_VG6
    s_mov_b32 s73, 0
    s_cmp_eq_u32 s76, 0
    s_cbranch_scc1 RN_Db6
    s_waitcnt lgkmcnt(0)
    s_min_u32 s69, s98, 0x10000
    s_add_u32 s69, s69, 816
    s_cmp_lt_u32 s56, 0x1000
    s_cselect_b32 s69, s69, 0x10000
    s_sub_u32 s101, s75, 1
    s_mov_b32 s75, 0
    s_mov_b32 s76, 0
RN_Db6:
    s_cmp_lt_u32 s69, 2048
    s_cbranch_scc1 IS_K6
    s_mov_b32 s73, 1
    s_mov_b32 s70, 0
    s_mov_b32 s74, 0x40000000
    s_branch IS_D6
IS_VG6:
    s_and_b32 s71, s57, 63
    v_readlane_b32 s74, v58, s71
    s_add_u32 s57, s57, 1
    s_mov_b32 s70, 2
    s_nop 2
IS_D6:
    s_cmp_eq_u32 s70, 1
    s_cbranch_scc1 FI_K7
    buffer_load_dwordx4 v[80:83], v2, s[8:11], s74 offen offset:0 nt
    buffer_load_dwordx4 v[84:87], v2, s[8:11], s74 offen offset:1024 nt
    buffer_load_dwordx4 v[88:91], v2, s[8:11], s74 offen offset:2048 nt
    buffer_load_dwordx4 v[92:95], v2, s[8:11], s74 offen offset:3072 nt
    s_branch FI_D7
FI_K7:
    buffer_load_dwordx4 v[80:83], v1, s[4:7], s74 offen offset:0 nt
    buffer_load_dwordx4 v[84:87], v1, s[4:7], s74 offen offset:1024 nt
    buffer_load_dwordx4 v[88:91], v1, s[4:7], s74 offen offset:2048 nt
    buffer_load_dwordx4 v[92:95], v1, s[4:7], s74 offen offset:3072 nt
FI_D7:
    s_mov_b32 s61, s70
    s_mov_b32 s65, s71
    v_mov_b32 v34, v54
    v_mov_b32 v35, v55
    v_mov_b32 v36, v56
    v_mov_b32 v37, v57
    s_nop 1
    v_permlane32_swap_b32 v34, v54
    v_permlane32_swap_b32 v35, v55
    v_permlane32_swap_b32 v36, v56
    v_permlane32_swap_b32 v37, v57
    s_nop 0
    v_add_f32 v54, v34, v54
    v_add_f32 v55, v35, v55
    v_add_f32 v56, v36, v56
    v_add_f32 v57, v37, v57
    v_cvt_pk_bf16_f32 v34, v54, v55
    v_cvt_pk_bf16_f32 v35, v56, v57
    v_and_b32 v13, 1, v5
    v_lshlrev_b32 v13, 3, v13
    v_lshl_or_b32 v13, v4, 4, v13
    ds_write_b64 v13, v[34:35] offset:0
    v_mov_b32 v13, 0
    v_mov_b32 v14, s55
    s_waitcnt lgkmcnt(0)
    ds_write_b32 v13, v14 offset:1028
    s_mov_b32 s77, s55
    s_branch A_QGO
A_PACE:
    s_waitcnt vmcnt(0)
    s_cmp_lg_u32 s73, 0
    s_cbranch_scc1 IS_V8
    s_cmp_ge_u32 s99, 0x1000
    s_cbranch_scc1 IS_TOV8
    s_cmp_eq_u32 s76, 0
    s_cbranch_scc1 RN_Da8
    s_waitcnt lgkmcnt(0)
    s_min_u32 s69, s98, 0x10000
    s_add_u32 s69, s69, 816
    s_cmp_lt_u32 s56, 0x1000
    s_cselect_b32 s69, s69, 0x10000
    s_sub_u32 s101, s75, 1
    s_mov_b32 s75, 0
    s_mov_b32 s76, 0
RN_Da8:
    s_cmp_ge_u32 s69, 2048
    s_cbranch_scc1 IS_TOV8
    s_cmp_ge_u32 s69, 1824
    s_cselect_b32 s99, 0x1000, s99
    s_cbranch_scc1 IS_TOV8
    s_sub_u32 s53, s72, s57
    s_cmp_ge_u32 s53, 40
    s_cbranch_scc1 IS_VG8
IS_K8:
    s_lshl_b32 s74, s69, 12
    s_xor_b32 s74, s74, s3
    s_and_b32 s71, s72, 63
    s_mov_b32 m0, s71
    s_add_u32 s72, s72, 1
    s_mov_b32 s70, 1
    v_writelane_b32 v58, s74, m0
    s_add_u32 s56, s56, 1
    s_cmp_lt_u32 s56, 26
    s_cbranch_scc1 GN_ST8
    s_cmp_eq_u32 s101, 0
    s_cselect_b32 s76, 1, 0
    s_add_u32 s69, s69, s101
    s_mov_b32 s101, 0
    s_branch GN_L8
GN_ST8:
    s_add_u32 s69, s69, 32
    s_cmp_lt_u32 s56, 25
    s_cbranch_scc1 GN_D8
GN_L8:
    s_cmp_lg_u32 s75, 0
    s_cbranch_scc1 GN_D8
    s_cmp_lt_u32 s69, 1728
    s_cselect_b32 s75, 2, 1
    s_mov_b32 s98, s75
    s_atomic_add s98, s[96:97], 0x0 glc
GN_D8:
    s_branch IS_D8
IS_TOV8:
    s_mov_b32 s73, 1
IS_V8:
    s_cmp_lg_u32 s57, s72
    s_cbranch_scc1 IS_VG8
    s_mov_b32 s73, 0
    s_cmp_eq_u32 s76, 0
    s_cbranch_scc1 RN_Db8
    s_waitcnt lgkmcnt(0)
    s_min_u32 s69, s98, 0x10000
    s_add_u32 s69, s69, 816
    s_cmp_lt_u32 s56, 0x1000
    s_cselect_b32 s69, s69, 0x10000
    s_sub_u32 s101, s75, 1
    s_mov_b32 s75, 0
    s_mov_b32 s76, 0
RN_Db8:
    s_cmp_lt_u32 s69, 2048
    s_cbranch_scc1 IS_K8
    s_mov_b32 s73, 1
    s_mov_b32 s70, 0
    s_mov_b32 s74, 0x40000000
    s_branch IS_D8
IS_VG8:
    s_and_b32 s71, s57, 63
    v_readlane_b32 s74, v58, s71
    s_add_u32 s57, s57, 1
    s_mov_b32 s70, 2
    s_nop 2
IS_D8:
    s_cmp_eq_u32 s70, 1
    s_cbranch_scc1 FI_K9
    buffer_load_dwordx4 v[64:67], v2, s[8:11], s74 offen offset:0 nt
    buffer_load_dwordx4 v[68:71], v2, s[8:11], s74 offen offset:1024 nt
    buffer_load_dwordx4 v[72:75], v2, s[8:11], s74 offen offset:2048 nt
    buffer_load_dwordx4 v[76:79], v2, s[8:11], s74 offen offset:3072 nt
    s_branch FI_D9
FI_K9:
    buffer_load_dwordx4 v[64:67], v1, s[4:7], s74 offen offset:0 nt
    buffer_load_dwordx4 v[68:71], v1, s[4:7], s74 offen offset:1024 nt
    buffer_load_dwordx4 v[72:75], v1, s[4:7], s74 offen offset:2048 nt
    buffer_load_dwordx4 v[76:79], v1, s[4:7], s74 offen offset:3072 nt
FI_D9:
    s_mov_b32 s60, s70
    s_mov_b32 s64, s71
    s_cmp_lg_u32 s73, 0
    s_cbranch_scc1 IS_V10
    s_cmp_ge_u32 s99, 0x1000
    s_cbranch_scc1 IS_TOV10
    s_cmp_eq_u32 s76, 0
    s_cbranch_scc1 RN_Da10
    s_waitcnt lgkmcnt(0)
    s_min_u32 s69, s98, 0x10000
    s_add_u32 s69, s69, 816
    s_cmp_lt_u32 s56, 0x1000
    s_cselect_b32 s69, s69, 0x10000
    s_sub_u32 s101, s75, 1
    s_mov_b32 s75, 0
    s_mov_b32 s76, 0
RN_Da10:
    s_cmp_ge_u32 s69, 2048
    s_cbranch_scc1 IS_TOV10
    s_cmp_ge_u32 s69, 1824
    s_cselect_b32 s99, 0x1000, s99
    s_cbranch_scc1 IS_TOV10
    s_sub_u32 s53, s72, s57
    s_cmp_ge_u32 s53, 40
    s_cbranch_scc1 IS_VG10
IS_K10:
    s_lshl_b32 s74, s69, 12
    s_xor_b32 s74, s74, s3
    s_and_b32 s71, s72, 63
    s_mov_b32 m0, s71
    s_add_u32 s72, s72, 1
    s_mov_b32 s70, 1
    v_writelane_b32 v58, s74, m0
    s_add_u32 s56, s56, 1
    s_cmp_lt_u32 s56, 26
    s_cbranch_scc1 GN_ST10
    s_cmp_eq_u32 s101, 0
    s_cselect_b32 s76, 1, 0
    s_add_u32 s69, s69, s101
    s_mov_b32 s101, 0
    s_branch GN_L10
GN_ST10:
    s_add_u32 s69, s69, 32
    s_cmp_lt_u32 s56, 25
    s_cbranch_scc1 GN_D10
GN_L10:
    s_cmp_lg_u32 s75, 0
    s_cbranch_scc1 GN_D10
    s_cmp_lt_u32 s69, 1728
    s_cselect_b32 s75, 2, 1
    s_mov_b32 s98, s75
    s_atomic_add s98, s[96:97], 0x0 glc
GN_D10:
    s_branch IS_D10
IS_TOV10:
    s_mov_b32 s73, 1
IS_V10:
    s_cmp_lg_u32 s57, s72
    s_cbranch_scc1 IS_VG10
    s_mov_b32 s73, 0
    s_cmp_eq_u32 s76, 0
    s_cbranch_scc1 RN_Db10
    s_waitcnt lgkmcnt(0)
    s_min_u32 s69, s98, 0x10000
    s_add_u32 s69, s69, 816
    s_cmp_lt_u32 s56, 0x1000
    s_cselect_b32 s69, s69, 0x10000
    s_sub_u32 s101, s75, 1
    s_mov_b32 s75, 0
    s_mov_b32 s76, 0
RN_Db10:
    s_cmp_lt_u32 s69, 2048
    s_cbranch_scc1 IS_K10
    s_mov_b32 s73, 1
    s_mov_b32 s70, 0
    s_mov_b32 s74, 0x40000000
    s_branch IS_D10
IS_VG10:
    s_and_b32 s71, s57, 63
    v_readlane_b32 s74, v58, s71
    s_add_u32 s57, s57, 1
    s_mov_b32 s70, 2
    s_nop 2
IS_D10:
    s_cmp_eq_u32 s70, 1
    s_cbranch_scc1 FI_K11
    buffer_load_dwordx4 v[80:83], v2, s[8:11], s74 offen offset:0 nt
    buffer_load_dwordx4 v[84:87], v2, s[8:11], s74 offen offset:1024 nt
    buffer_load_dwordx4 v[88:91], v2, s[8:11], s74 offen offset:2048 nt
    buffer_load_dwordx4 v[92:95], v2, s[8:11], s74 offen offset:3072 nt
    s_branch FI_D11
FI_K11:
    buffer_load_dwordx4 v[80:83], v1, s[4:7], s74 offen offset:0 nt
    buffer_load_dwordx4 v[84:87], v1, s[4:7], s74 offen offset:1024 nt
    buffer_load_dwordx4 v[88:91], v1, s[4:7], s74 offen offset:2048 nt
    buffer_load_dwordx4 v[92:95], v1, s[4:7], s74 offen offset:3072 nt
FI_D11:
    s_mov_b32 s61, s70
    s_mov_b32 s65, s71
A_QSPIN:
    s_cmp_lg_u32 s77, 0
    s_cbranch_scc1 A_QGO
    v_mov_b32 v13, 0
    ds_read_b32 v14, v13 offset:1028
    s_waitcnt lgkmcnt(0)
    v_readfirstlane_b32 s77, v14
    s_add_u32 s76, s76, 1
    s_cmp_gt_u32 s76, 0x4000000
    s_cbranch_scc1 A_QGO
    s_branch A_QSPIN
A_QGO:
    s_mov_b32 s76, 0
    v_and_b32 v13, 3, v4
    v_lshlrev_b32 v13, 4, v13
    v_lshl_or_b32 v13, v5, 6, v13
    ds_read_b128 v[34:37], v13 offset:0
    v_lshrrev_b32 v14, 2, v4
    v_mov_b32 v54, 0
    v_mov_b32 v55, 0
    v_mov_b32 v56, 0
    v_mov_b32 v57, 0
    s_waitcnt lgkmcnt(0)
    v_cmp_eq_u32 vcc, 0, v14
    s_nop 1
    v_cndmask_b32 v38, 0, v34, vcc
    v_cndmask_b32 v39, 0, v35, vcc
    v_cndmask_b32 v40, 0, v36, vcc
    v_cndmask_b32 v41, 0, v37, vcc
    v_cmp_eq_u32 vcc, 1, v14
    s_nop 1
    v_cndmask_b32 v42, 0, v34, vcc
    v_cndmask_b32 v43, 0, v35, vcc
    v_cndmask_b32 v44, 0, v36, vcc
    v_cndmask_b32 v45, 0, v37, vcc
    v_cmp_eq_u32 vcc, 2, v14
    s_nop 1
    v_cndmask_b32 v46, 0, v34, vcc
    v_cndmask_b32 v47, 0, v35, vcc
    v_cndmask_b32 v48, 0, v36, vcc
    v_cndmask_b32 v49, 0, v37, vcc
    v_cmp_eq_u32 vcc, 3, v14
    s_nop 1
    v_cndmask_b32 v50, 0, v34, vcc
    v_cndmask_b32 v51, 0, v35, vcc
    v_cndmask_b32 v52, 0, v36, vcc
    v_cndmask_b32 v53, 0, v37, vcc
    s_nop 1
    v_lshrrev_b32 v59, 2, v0
    v_lshlrev_b32 v59, 2, v59
    s_lshl_b32 s53, s50, 12
    v_add_u32 v59, s53, v59
    s_memrealtime s[94:95]
    s_mov_b32 s78, 0
    s_cmp_eq_u32 s50, 0
    s_cbranch_scc1 A_LOOP
    s_lshl_b32 s53, s66, 6
    v_add_u32 v19, s53, v59
    v_mfma_f32_16x16x32_bf16 v[34:37], v[96:99], v[38:41], 0
    v_mfma_f32_16x16x32_bf16 v[34:37], v[100:103], v[42:45], v[34:37]
    v_mfma_f32_16x16x32_bf16 v[34:37], v[104:107], v[46:49], v[34:37]
    v_mfma_f32_16x16x32_bf16 v[34:37], v[108:111], v[50:53], v[34:37]
    s_nop 7
    v_mov_b32_dpp v13, v34 quad_perm:[0,0,0,0] row_mask:0xf bank_mask:0xf
    v_add_f32_dpp v13, v35, v13 quad_perm:[1,1,1,1] row_mask:0xf bank_mask:0xf
    v_add_f32_dpp v13, v36, v13 quad_perm:[2,2,2,2] row_mask:0xf bank_mask:0xf
    v_add_f32_dpp v13, v37, v13 quad_perm:[3,3,3,3] row_mask:0xf bank_mask:0xf
    v_cvt_pk_bf16_f32 v13, v13, v13
    v_and_b32 v13, 0xffff0000, v13
    v_mul_f32 v13, s58, v13
    v_cvt_pk_bf16_f32 v13, v13, v13
    v_and_b32 v13, 0xffff0000, v13
    ds_write_b32 v19, v13 offset:12288
    v_cmp_gt_f32 vcc, v13, v10
    s_cbranch_vccnz A_RAREX0
A_NEXTX0:
    s_lshl_b32 s53, s67, 6
    v_add_u32 v19, s53, v59
    v_mfma_f32_16x16x32_bf16 v[34:37], v[112:115], v[38:41], 0
    v_mfma_f32_16x16x32_bf16 v[34:37], v[116:119], v[42:45], v[34:37]
    v_mfma_f32_16x16x32_bf16 v[34:37], v[120:123], v[46:49], v[34:37]
    v_mfma_f32_16x16x32_bf16 v[34:37], v[124:127], v[50:53], v[34:37]
    s_nop 7
    v_mov_b32_dpp v13, v34 quad_perm:[0,0,0,0] row_mask:0xf bank_mask:0xf
    v_add_f32_dpp v13, v35, v13 quad_perm:[1,1,1,1] row_mask:0xf bank_mask:0xf
    v_add_f32_dpp v13, v36, v13 quad_perm:[2,2,2,2] row_mask:0xf bank_mask:0xf
    v_add_f32_dpp v13, v37, v13 quad_perm:[3,3,3,3] row_mask:0xf bank_mask:0xf
    v_cvt_pk_bf16_f32 v13, v13, v13
    v_and_b32 v13, 0xffff0000, v13
    v_mul_f32 v13, s58, v13
    v_cvt_pk_bf16_f32 v13, v13, v13
    v_and_b32 v13, 0xffff0000, v13
    ds_write_b32 v19, v13 offset:12288
    v_cmp_gt_f32 vcc, v13, v10
    s_cbranch_vccnz A_RAREX1
A_NEXTX1:
A_LOOP:
    s_cmp_eq_u32 s60, 0
    s_cbranch_scc1 A_EXIT
    s_lshl_b32 s53, s64, 6
    v_add_u32 v19, s53, v59
    s_cmp_eq_u32 s60, 2
    s_cbranch_scc1 A_PV0
    s_cmp_lg_u32 s76, 0
    s_cbranch_scc1 IS_CK12
    s_cmp_lg_u32 s75, 0
    s_cbranch_scc1 IS_CS12
IS_CK12:
    s_waitcnt lgkmcnt(0)
    s_sub_u32 s78, s94, s77
    s_memrealtime s[94:95]
IS_CS12:
    s_cmp_lg_u32 s73, 0
    s_cbranch_scc1 IS_V12
    s_cmp_ge_u32 s99, 0x1000
    s_cbranch_scc1 IS_TOV12
    s_bitcmp0_b32 s78, 11
    s_cbranch_scc1 IS_KT12
    s_cmp_lg_u32 s57, s72
    s_cbranch_scc1 IS_VG12
IS_KT12:
    s_cmp_eq_u32 s76, 0
    s_cbranch_scc1 RN_Da12
    s_min_u32 s69, s98, 0x10000
    s_add_u32 s69, s69, 816
    s_cmp_lt_u32 s56, 0x1000
    s_cselect_b32 s69, s69, 0x10000
    s_sub_u32 s101, s75, 1
    s_mov_b32 s75, 0
    s_mov_b32 s76, 0
RN_Da12:
    s_cmp_ge_u32 s69, 2048
    s_cbranch_scc1 IS_TOV12
    s_cmp_ge_u32 s69, 1824
    s_cselect_b32 s99, 0x1000, s99
    s_cbranch_scc1 IS_TOV12
    s_sub_u32 s53, s72, s57
    s_cmp_ge_u32 s53, 40
    s_cbranch_scc1 IS_VG12
IS_K12:
    s_lshl_b32 s74, s69, 12
    s_xor_b32 s74, s74, s3
    s_and_b32 s71, s72, 63
    s_mov_b32 m0, s71
    s_add_u32 s72, s72, 1
    s_mov_b32 s70, 1
    v_writelane_b32 v58, s74, m0
    s_add_u32 s56, s56, 1
    s_cmp_lt_u32 s56, 26
    s_cbranch_scc1 GN_ST12
    s_cmp_eq_u32 s101, 0
    s_cselect_b32 s76, 1, 0
    s_add_u32 s69, s69, s101
    s_mov_b32 s101, 0
    s_branch GN_L12
GN_ST12:
    s_add_u32 s69, s69, 32
    s_cmp_lt_u32 s56, 25
    s_cbranch_scc1 GN_D12
GN_L12:
    s_cmp_lg_u32 s75, 0
    s_cbranch_scc1 GN_D12
    s_cmp_lt_u32 s69, 1728
    s_cselect_b32 s75, 2, 1
    s_mov_b32 s98, s75
    s_atomic_add s98, s[96:97], 0x0 glc
GN_D12:
    s_branch IS_D12
IS_TOV12:
    s_mov_b32 s73, 1
IS_V12:
    s_cmp_lg_u32 s57, s72
    s_cbranch_scc1 IS_VG12
    s_mov_b32 s73, 0
    s_cmp_eq_u32 s76, 0
    s_cbranch_scc1 RN_Db12
    s_min_u32 s69, s98, 0x10000
    s_add_u32 s69, s69, 816
    s_cmp_lt_u32 s56, 0x1000
    s_cselect_b32 s69, s69, 0x10000
    s_sub_u32 s101, s75, 1
    s_mov_b32 s75, 0
    s_mov_b32 s76, 0
RN_Db12:
    s_cmp_lt_u32 s69, 2048
    s_cbranch_scc1 IS_K12
    s_mov_b32 s73, 1
    s_mov_b32 s70, 0
    s_mov_b32 s74, 0x40000000
    s_branch IS_D12
IS_VG12:
    s_and_b32 s71, s57, 63
    v_readlane_b32 s74, v58, s71
    s_add_u32 s57, s57, 1
    s_mov_b32 s70, 2
    s_nop 2
IS_D12:
    s_waitcnt vmcnt(4)
    v_mfma_f32_16x16x32_bf16 v[34:37], v[64:67], v[38:41], 0
    v_mfma_f32_16x16x32_bf16 v[34:37], v[68:71], v[42:45], v[34:37]
    v_mfma_f32_16x16x32_bf16 v[34:37], v[72:75], v[46:49], v[34:37]
    v_mfma_f32_16x16x32_bf16 v[34:37], v[76:79], v[50:53], v[34:37]
    s_cmp_eq_u32 s70, 1
    s_cbranch_scc1 FI_K13
    buffer_load_dwordx4 v[64:67], v2, s[8:11], s74 offen offset:0 nt
    buffer_load_dwordx4 v[68:71], v2, s[8:11], s74 offen offset:1024 nt
    buffer_load_dwordx4 v[72:75], v2, s[8:11], s74 offen offset:2048 nt
    buffer_load_dwordx4 v[76:79], v2, s[8:11], s74 offen offset:3072 nt
    s_branch FI_D13
FI_K13:
    buffer_load_dwordx4 v[64:67], v1, s[4:7], s74 offen offset:0 nt
    buffer_load_dwordx4 v[68:71], v1, s[4:7], s74 offen offset:1024 nt
    buffer_load_dwordx4 v[72:75], v1, s[4:7], s74 offen offset:2048 nt
    buffer_load_dwordx4 v[76:79], v1, s[4:7], s74 offen offset:3072 nt
FI_D13:
    s_mov_b32 s60, s70
    s_mov_b32 s64, s71
    s_nop 0
    v_mov_b32_dpp v13, v34 quad_perm:[0,0,0,0] row_mask:0xf bank_mask:0xf
    v_add_f32_dpp v13, v35, v13 quad_perm:[1,1,1,1] row_mask:0xf bank_mask:0xf
    v_add_f32_dpp v13, v36, v13 quad_perm:[2,2,2,2] row_mask:0xf bank_mask:0xf
    v_add_f32_dpp v13, v37, v13 quad_perm:[3,3,3,3] row_mask:0xf bank_mask:0xf
    v_cvt_pk_bf16_f32 v13, v13, v13
    v_and_b32 v13, 0xffff0000, v13
    v_mul_f32 v13, s58, v13
    v_cvt_pk_bf16_f32 v13, v13, v13
    v_and_b32 v13, 0xffff0000, v13
    ds_write_b32 v19, v13 offset:12288
    v_cmp_gt_f32 vcc, v13, v10
    s_cbranch_vccnz A_RARE0
    s_branch A_NEXT0
A_PV0:
    ds_read_b32 v13, v19 offset:12288
    s_waitcnt lgkmcnt(0)
IS_CK14:
    s_waitcnt lgkmcnt(0)
    s_sub_u32 s78, s94, s77
    s_memrealtime s[94:95]
IS_CS14:
    s_cmp_lg_u32 s73, 0
    s_cbranch_scc1 IS_V14
    s_cmp_ge_u32 s99, 0x1000
    s_cbranch_scc1 IS_TOV14
    s_bitcmp0_b32 s78, 11
    s_cbranch_scc1 IS_KT14
    s_cmp_lg_u32 s57, s72
    s_cbranch_scc1 IS_VG14
IS_KT14:
    s_cmp_eq_u32 s76, 0
    s_cbranch_scc1 RN_Da14
    s_min_u32 s69, s98, 0x10000
    s_add_u32 s69, s69, 816
    s_cmp_lt_u32 s56, 0x1000
    s_cselect_b32 s69, s69, 0x10000
    s_sub_u32 s101, s75, 1
    s_mov_b32 s75, 0
    s_mov_b32 s76, 0
RN_Da14:
    s_cmp_ge_u32 s69, 2048
    s_cbranch_scc1 IS_TOV14
    s_cmp_ge_u32 s69, 1824
    s_cselect_b32 s99, 0x1000, s99
    s_cbranch_scc1 IS_TOV14
    s_sub_u32 s53, s72, s57
    s_cmp_ge_u32 s53, 40
    s_cbranch_scc1 IS_VG14
IS_K14:
    s_lshl_b32 s74, s69, 12
    s_xor_b32 s74, s74, s3
    s_and_b32 s71, s72, 63
    s_mov_b32 m0, s71
    s_add_u32 s72, s72, 1
    s_mov_b32 s70, 1
    v_writelane_b32 v58, s74, m0
    s_add_u32 s56, s56, 1
    s_cmp_lt_u32 s56, 26
    s_cbranch_scc1 GN_ST14
    s_cmp_eq_u32 s101, 0
    s_cselect_b32 s76, 1, 0
    s_add_u32 s69, s69, s101
    s_mov_b32 s101, 0
    s_branch GN_L14
GN_ST14:
    s_add_u32 s69, s69, 32
    s_cmp_lt_u32 s56, 25
    s_cbranch_scc1 GN_D14
GN_L14:
    s_cmp_lg_u32 s75, 0
    s_cbranch_scc1 GN_D14
    s_cmp_lt_u32 s69, 1728
    s_cselect_b32 s75, 2, 1
    s_mov_b32 s98, s75
    s_atomic_add s98, s[96:97], 0x0 glc
GN_D14:
    s_branch IS_D14
IS_TOV14:
    s_mov_b32 s73, 1
IS_V14:
    s_cmp_lg_u32 s57, s72
    s_cbranch_scc1 IS_VG14
    s_mov_b32 s73, 0
    s_cmp_eq_u32 s76, 0
    s_cbranch_scc1 RN_Db14
    s_min_u32 s69, s98, 0x10000
    s_add_u32 s69, s69, 816
    s_cmp_lt_u32 s56, 0x1000
    s_cselect_b32 s69, s69, 0x10000
    s_sub_u32 s101, s75, 1
    s_mov_b32 s75, 0
    s_mov_b32 s76, 0
RN_Db14:
    s_cmp_lt_u32 s69, 2048
    s_cbranch_scc1 IS_K14
    s_mov_b32 s73, 1
    s_mov_b32 s70, 0
    s_mov_b32 s74, 0x40000000
    s_branch IS_D14
IS_VG14:
    s_and_b32 s71, s57, 63
    v_readlane_b32 s74, v58, s71
    s_add_u32 s57, s57, 1
    s_mov_b32 s70, 2
    s_nop 2
IS_D14:
    v_fma_f32 v14, v13, s59, -v11
    v_exp_f32 v14, v14
    s_nop 0
    v_cvt_pk_bf16_f32 v15, v14, v14
    v_add_f32 v12, v12, v14
    s_nop 0
    v_and_b32_dpp v22, v15, v6 row_newbcast:0 row_mask:0xf bank_mask:0xf
    v_and_b32_dpp v23, v15, v7 row_newbcast:0 row_mask:0xf bank_mask:0xf
    v_and_b32_dpp v24, v15, v8 row_newbcast:0 row_mask:0xf bank_mask:0xf
    v_and_b32_dpp v25, v15, v9 row_newbcast:0 row_mask:0xf bank_mask:0xf
    v_and_b32_dpp v26, v15, v6 row_newbcast:4 row_mask:0xf bank_mask:0xf
    v_and_b32_dpp v27, v15, v7 row_newbcast:4 row_mask:0xf bank_mask:0xf
    v_and_b32_dpp v28, v15, v8 row_newbcast:4 row_mask:0xf bank_mask:0xf
    v_and_b32_dpp v29, v15, v9 row_newbcast:4 row_mask:0xf bank_mask:0xf
    s_waitcnt vmcnt(4)
    v_mfma_f32_16x16x32_bf16 v[54:57], v[22:25], v[64:67], v[54:57]
    v_and_b32_dpp v22, v15, v6 row_newbcast:8 row_mask:0xf bank_mask:0xf
    v_and_b32_dpp v23, v15, v7 row_newbcast:8 row_mask:0xf bank_mask:0xf
    v_and_b32_dpp v24, v15, v8 row_newbcast:8 row_mask:0xf bank_mask:0xf
    v_and_b32_dpp v25, v15, v9 row_newbcast:8 row_mask:0xf bank_mask:0xf
    v_mfma_f32_16x16x32_bf16 v[54:57], v[26:29], v[68:71], v[54:57]
    v_and_b32_dpp v26, v15, v6 row_newbcast:12 row_mask:0xf bank_mask:0xf
    v_and_b32_dpp v27, v15, v7 row_newbcast:12 row_mask:0xf bank_mask:0xf
    v_and_b32_dpp v28, v15, v8 row_newbcast:12 row_mask:0xf bank_mask:0xf
    v_and_b32_dpp v29, v15, v9 row_newbcast:12 row_mask:0xf bank_mask:0xf
    v_mfma_f32_16x16x32_bf16 v[54:57], v[22:25], v[72:75], v[54:57]
    s_nop 0
    v_mfma_f32_16x16x32_bf16 v[54:57], v[26:29], v[76:79], v[54:57]
    s_cmp_eq_u32 s70, 1
    s_cbranch_scc1 FI_K15
    buffer_load_dwordx4 v[64:67], v2, s[8:11], s74 offen offset:0 nt
    buffer_load_dwordx4 v[68:71], v2, s[8:11], s74 offen offset:1024 nt
    buffer_load_dwordx4 v[72:75], v2, s[8:11], s74 offen offset:2048 nt
    buffer_load_dwordx4 v[76:79], v2, s[8:11], s74 offen offset:3072 nt
    s_branch FI_D15
FI_K15:
    buffer_load_dwordx4 v[64:67], v1, s[4:7], s74 offen offset:0 nt
    buffer_load_dwordx4 v[68:71], v1, s[4:7], s74 offen offset:1024 nt
    buffer_load_dwordx4 v[72:75], v1, s[4:7], s74 offen offset:2048 nt
    buffer_load_dwordx4 v[76:79], v1, s[4:7], s74 offen offset:3072 nt
FI_D15:
    s_mov_b32 s60, s70
    s_mov_b32 s64, s71
A_NEXT0:
    s_cmp_eq_u32 s61, 0
    s_cbranch_scc1 A_EXIT
    s_lshl_b32 s53, s65, 6
    v_add_u32 v19, s53, v59
    s_cmp_eq_u32 s61, 2
    s_cbranch_scc1 A_PV1
    s_cmp_lg_u32 s76, 0
    s_cbranch_scc1 IS_CK16
    s_cmp_lg_u32 s75, 0
    s_cbranch_scc1 IS_CS16
IS_CK16:
    s_waitcnt lgkmcnt(0)
    s_sub_u32 s78, s94, s77
    s_memrealtime s[94:95]
IS_CS16:
    s_cmp_lg_u32 s73, 0
    s_cbranch_scc1 IS_V16
    s_cmp_ge_u32 s99, 0x1000
    s_cbranch_scc1 IS_TOV16
    s_bitcmp0_b32 s78, 11
    s_cbranch_scc1 IS_KT16
    s_cmp_lg_u32 s57, s72
    s_cbranch_scc1 IS_VG16
IS_KT16:
    s_cmp_eq_u32 s76, 0
    s_cbranch_scc1 RN_Da16
    s_min_u32 s69, s98, 0x10000
    s_add_u32 s69, s69, 816
    s_cmp_lt_u32 s56, 0x1000
    s_cselect_b32 s69, s69, 0x10000
    s_sub_u32 s101, s75, 1
    s_mov_b32 s75, 0
    s_mov_b32 s76, 0
RN_Da16:
    s_cmp_ge_u32 s69, 2048
    s_cbranch_scc1 IS_TOV16
    s_cmp_ge_u32 s69, 1824
    s_cselect_b32 s99, 0x1000, s99
    s_cbranch_scc1 IS_TOV16
    s_sub_u32 s53, s72, s57
    s_cmp_ge_u32 s53, 40
    s_cbranch_scc1 IS_VG16
IS_K16:
    s_lshl_b32 s74, s69, 12
    s_xor_b32 s74, s74, s3
    s_and_b32 s71, s72, 63
    s_mov_b32 m0, s71
    s_add_u32 s72, s72, 1
    s_mov_b32 s70, 1
    v_writelane_b32 v58, s74, m0
    s_add_u32 s56, s56, 1
    s_cmp_lt_u32 s56, 26
    s_cbranch_scc1 GN_ST16
    s_cmp_eq_u32 s101, 0
    s_cselect_b32 s76, 1, 0
    s_add_u32 s69, s69, s101
    s_mov_b32 s101, 0
    s_branch GN_L16
GN_ST16:
    s_add_u32 s69, s69, 32
    s_cmp_lt_u32 s56, 25
    s_cbranch_scc1 GN_D16
GN_L16:
    s_cmp_lg_u32 s75, 0
    s_cbranch_scc1 GN_D16
    s_cmp_lt_u32 s69, 1728
    s_cselect_b32 s75, 2, 1
    s_mov_b32 s98, s75
    s_atomic_add s98, s[96:97], 0x0 glc
GN_D16:
    s_branch IS_D16
IS_TOV16:
    s_mov_b32 s73, 1
IS_V16:
    s_cmp_lg_u32 s57, s72
    s_cbranch_scc1 IS_VG16
    s_mov_b32 s73, 0
    s_cmp_eq_u32 s76, 0
    s_cbranch_scc1 RN_Db16
    s_min_u32 s69, s98, 0x10000
    s_add_u32 s69, s69, 816
    s_cmp_lt_u32 s56, 0x1000
    s_cselect_b32 s69, s69, 0x10000
    s_sub_u32 s101, s75, 1
    s_mov_b32 s75, 0
    s_mov_b32 s76, 0
RN_Db16:
    s_cmp_lt_u32 s69, 2048
    s_cbranch_scc1 IS_K16
    s_mov_b32 s73, 1
    s_mov_b32 s70, 0
    s_mov_b32 s74, 0x40000000
    s_branch IS_D16
IS_VG16:
    s_and_b32 s71, s57, 63
    v_readlane_b32 s74, v58, s71
    s_add_u32 s57, s57, 1
    s_mov_b32 s70, 2
    s_nop 2
IS_D16:
    s_waitcnt vmcnt(4)
    v_mfma_f32_16x16x32_bf16 v[34:37], v[80:83], v[38:41], 0
    v_mfma_f32_16x16x32_bf16 v[34:37], v[84:87], v[42:45], v[34:37]
    v_mfma_f32_16x16x32_bf16 v[34:37], v[88:91], v[46:49], v[34:37]
    v_mfma_f32_16x16x32_bf16 v[34:37], v[92:95], v[50:53], v[34:37]
    s_cmp_eq_u32 s70, 1
    s_cbranch_scc1 FI_K17
    buffer_load_dwordx4 v[80:83], v2, s[8:11], s74 offen offset:0 nt
    buffer_load_dwordx4 v[84:87], v2, s[8:11], s74 offen offset:1024 nt
    buffer_load_dwordx4 v[88:91], v2, s[8:11], s74 offen offset:2048 nt
    buffer_load_dwordx4 v[92:95], v2, s[8:11], s74 offen offset:3072 nt
    s_branch FI_D17
FI_K17:
    buffer_load_dwordx4 v[80:83], v1, s[4:7], s74 offen offset:0 nt
    buffer_load_dwordx4 v[84:87], v1, s[4:7], s74 offen offset:1024 nt
    buffer_load_dwordx4 v[88:91], v1, s[4:7], s74 offen offset:2048 nt
    buffer_load_dwordx4 v[92:95], v1, s[4:7], s74 offen offset:3072 nt
FI_D17:
    s_mov_b32 s61, s70
    s_mov_b32 s65, s71
    s_nop 0
    v_mov_b32_dpp v13, v34 quad_perm:[0,0,0,0] row_mask:0xf bank_mask:0xf
    v_add_f32_dpp v13, v35, v13 quad_perm:[1,1,1,1] row_mask:0xf bank_mask:0xf
    v_add_f32_dpp v13, v36, v13 quad_perm:[2,2,2,2] row_mask:0xf bank_mask:0xf
    v_add_f32_dpp v13, v37, v13 quad_perm:[3,3,3,3] row_mask:0xf bank_mask:0xf
    v_cvt_pk_bf16_f32 v13, v13, v13
    v_and_b32 v13, 0xffff0000, v13
    v_mul_f32 v13, s58, v13
    v_cvt_pk_bf16_f32 v13, v13, v13
    v_and_b32 v13, 0xffff0000, v13
    ds_write_b32 v19, v13 offset:12288
    v_cmp_gt_f32 vcc, v13, v10
    s_cbranch_vccnz A_RARE1
    s_branch A_NEXT1
A_PV1:
    ds_read_b32 v13, v19 offset:12288
    s_waitcnt lgkmcnt(0)
IS_CK18:
    s_waitcnt lgkmcnt(0)
    s_sub_u32 s78, s94, s77
    s_memrealtime s[94:95]
IS_CS18:
    s_cmp_lg_u32 s73, 0
    s_cbranch_scc1 IS_V18
    s_cmp_ge_u32 s99, 0x1000
    s_cbranch_scc1 IS_TOV18
    s_bitcmp0_b32 s78, 11
    s_cbranch_scc1 IS_KT18
    s_cmp_lg_u32 s57, s72
    s_cbranch_scc1 IS_VG18
IS_KT18:
    s_cmp_eq_u32 s76, 0
    s_cbranch_scc1 RN_Da18
    s_min_u32 s69, s98, 0x10000
    s_add_u32 s69, s69, 816
    s_cmp_lt_u32 s56, 0x1000
    s_cselect_b32 s69, s69, 0x10000
    s_sub_u32 s101, s75, 1
    s_mov_b32 s75, 0
    s_mov_b32 s76, 0
RN_Da18:
    s_cmp_ge_u32 s69, 2048
    s_cbranch_scc1 IS_TOV18
    s_cmp_ge_u32 s69, 1824
    s_cselect_b32 s99, 0x1000, s99
    s_cbranch_scc1 IS_TOV18
    s_sub_u32 s53, s72, s57
    s_cmp_ge_u32 s53, 40
    s_cbranch_scc1 IS_VG18
IS_K18:
    s_lshl_b32 s74, s69, 12
    s_xor_b32 s74, s74, s3
    s_and_b32 s71, s72, 63
    s_mov_b32 m0, s71
    s_add_u32 s72, s72, 1
    s_mov_b32 s70, 1
    v_writelane_b32 v58, s74, m0
    s_add_u32 s56, s56, 1
    s_cmp_lt_u32 s56, 26
    s_cbranch_scc1 GN_ST18
    s_cmp_eq_u32 s101, 0
    s_cselect_b32 s76, 1, 0
    s_add_u32 s69, s69, s101
    s_mov_b32 s101, 0
    s_branch GN_L18
GN_ST18:
    s_add_u32 s69, s69, 32
    s_cmp_lt_u32 s56, 25
    s_cbranch_scc1 GN_D18
GN_L18:
    s_cmp_lg_u32 s75, 0
    s_cbranch_scc1 GN_D18
    s_cmp_lt_u32 s69, 1728
    s_cselect_b32 s75, 2, 1
    s_mov_b32 s98, s75
    s_atomic_add s98, s[96:97], 0x0 glc
GN_D18:
    s_branch IS_D18
IS_TOV18:
    s_mov_b32 s73, 1
IS_V18:
    s_cmp_lg_u32 s57, s72
    s_cbranch_scc1 IS_VG18
    s_mov_b32 s73, 0
    s_cmp_eq_u32 s76, 0
    s_cbranch_scc1 RN_Db18
    s_min_u32 s69, s98, 0x10000
    s_add_u32 s69, s69, 816
    s_cmp_lt_u32 s56, 0x1000
    s_cselect_b32 s69, s69, 0x10000
    s_sub_u32 s101, s75, 1
    s_mov_b32 s75, 0
    s_mov_b32 s76, 0
RN_Db18:
    s_cmp_lt_u32 s69, 2048
    s_cbranch_scc1 IS_K18
    s_mov_b32 s73, 1
    s_mov_b32 s70, 0
    s_mov_b32 s74, 0x40000000
    s_branch IS_D18
IS_VG18:
    s_and_b32 s71, s57, 63
    v_readlane_b32 s74, v58, s71
    s_add_u32 s57, s57, 1
    s_mov_b32 s70, 2
    s_nop 2
IS_D18:
    v_fma_f32 v14, v13, s59, -v11
    v_exp_f32 v14, v14
    s_nop 0
    v_cvt_pk_bf16_f32 v15, v14, v14
    v_add_f32 v12, v12, v14
    s_nop 0
    v_and_b32_dpp v22, v15, v6 row_newbcast:0 row_mask:0xf bank_mask:0xf
    v_and_b32_dpp v23, v15, v7 row_newbcast:0 row_mask:0xf bank_mask:0xf
    v_and_b32_dpp v24, v15, v8 row_newbcast:0 row_mask:0xf bank_mask:0xf
    v_and_b32_dpp v25, v15, v9 row_newbcast:0 row_mask:0xf bank_mask:0xf
    v_and_b32_dpp v26, v15, v6 row_newbcast:4 row_mask:0xf bank_mask:0xf
    v_and_b32_dpp v27, v15, v7 row_newbcast:4 row_mask:0xf bank_mask:0xf
    v_and_b32_dpp v28, v15, v8 row_newbcast:4 row_mask:0xf bank_mask:0xf
    v_and_b32_dpp v29, v15, v9 row_newbcast:4 row_mask:0xf bank_mask:0xf
    s_waitcnt vmcnt(4)
    v_mfma_f32_16x16x32_bf16 v[54:57], v[22:25], v[80:83], v[54:57]
    v_and_b32_dpp v22, v15, v6 row_newbcast:8 row_mask:0xf bank_mask:0xf
    v_and_b32_dpp v23, v15, v7 row_newbcast:8 row_mask:0xf bank_mask:0xf
    v_and_b32_dpp v24, v15, v8 row_newbcast:8 row_mask:0xf bank_mask:0xf
    v_and_b32_dpp v25, v15, v9 row_newbcast:8 row_mask:0xf bank_mask:0xf
    v_mfma_f32_16x16x32_bf16 v[54:57], v[26:29], v[84:87], v[54:57]
    v_and_b32_dpp v26, v15, v6 row_newbcast:12 row_mask:0xf bank_mask:0xf
    v_and_b32_dpp v27, v15, v7 row_newbcast:12 row_mask:0xf bank_mask:0xf
    v_and_b32_dpp v28, v15, v8 row_newbcast:12 row_mask:0xf bank_mask:0xf
    v_and_b32_dpp v29, v15, v9 row_newbcast:12 row_mask:0xf bank_mask:0xf
    v_mfma_f32_16x16x32_bf16 v[54:57], v[22:25], v[88:91], v[54:57]
    s_nop 0
    v_mfma_f32_16x16x32_bf16 v[54:57], v[26:29], v[92:95], v[54:57]
    s_cmp_eq_u32 s70, 1
    s_cbranch_scc1 FI_K19
    buffer_load_dwordx4 v[80:83], v2, s[8:11], s74 offen offset:0 nt
    buffer_load_dwordx4 v[84:87], v2, s[8:11], s74 offen offset:1024 nt
    buffer_load_dwordx4 v[88:91], v2, s[8:11], s74 offen offset:2048 nt
    buffer_load_dwordx4 v[92:95], v2, s[8:11], s74 offen offset:3072 nt
    s_branch FI_D19
FI_K19:
    buffer_load_dwordx4 v[80:83], v1, s[4:7], s74 offen offset:0 nt
    buffer_load_dwordx4 v[84:87], v1, s[4:7], s74 offen offset:1024 nt
    buffer_load_dwordx4 v[88:91], v1, s[4:7], s74 offen offset:2048 nt
    buffer_load_dwordx4 v[92:95], v1, s[4:7], s74 offen offset:3072 nt
FI_D19:
    s_mov_b32 s61, s70
    s_mov_b32 s65, s71
A_NEXT1:
    s_branch A_LOOP
A_RAREX0:
    v_mov_b32 v16, v13
    s_nop 1
    v_max_f32_dpp v16, v16, v16 row_ror:4 row_mask:0xf bank_mask:0xf
    s_nop 1
    v_max_f32_dpp v16, v16, v16 row_ror:8 row_mask:0xf bank_mask:0xf
    v_mov_b32 v17, v16
    v_mov_b32 v18, v16
    s_nop 1
    v_permlane16_swap_b32 v17, v18
    s_nop 0
    v_max_f32 v16, v17, v18
    v_mov_b32 v17, v16
    v_mov_b32 v18, v16
    s_nop 1
    v_permlane32_swap_b32 v17, v18
    s_nop 0
    v_max_f32 v16, v17, v18
    v_mul_f32 v17, s59, v16
    v_sub_f32 v18, v11, v17
    v_exp_f32 v18, v18
    v_mov_b32 v10, v16
    v_mov_b32 v11, v17
    s_nop 7
    v_mul_f32 v12, v12, v18
    v_mul_f32 v54, v54, v18
    v_mul_f32 v55, v55, v18
    v_mul_f32 v56, v56, v18
    v_mul_f32 v57, v57, v18
    s_nop 1
    s_branch A_NEXTX0
A_RAREX1:
    v_mov_b32 v16, v13
    s_nop 1
    v_max_f32_dpp v16, v16, v16 row_ror:4 row_mask:0xf bank_mask:0xf
    s_nop 1
    v_max_f32_dpp v16, v16, v16 row_ror:8 row_mask:0xf bank_mask:0xf
    v_mov_b32 v17, v16
    v_mov_b32 v18, v16
    s_nop 1
    v_permlane16_swap_b32 v17, v18
    s_nop 0
    v_max_f32 v16, v17, v18
    v_mov_b32 v17, v16
    v_mov_b32 v18, v16
    s_nop 1
    v_permlane32_swap_b32 v17, v18
    s_nop 0
    v_max_f32 v16, v17, v18
    v_mul_f32 v17, s59, v16
    v_sub_f32 v18, v11, v17
    v_exp_f32 v18, v18
    v_mov_b32 v10, v16
    v_mov_b32 v11, v17
    s_nop 7
    v_mul_f32 v12, v12, v18
    v_mul_f32 v54, v54, v18
    v_mul_f32 v55, v55, v18
    v_mul_f32 v56, v56, v18
    v_mul_f32 v57, v57, v18
    s_nop 1
    s_branch A_NEXTX1
A_RARE0:
    v_mov_b32 v16, v13
    s_nop 1
    v_max_f32_dpp v16, v16, v16 row_ror:4 row_mask:0xf bank_mask:0xf
    s_nop 1
    v_max_f32_dpp v16, v16, v16 row_ror:8 row_mask:0xf bank_mask:0xf
    v_mov_b32 v17, v16
    v_mov_b32 v18, v16
    s_nop 1
    v_permlane16_swap_b32 v17, v18
    s_nop 0
    v_max_f32 v16, v17, v18
    v_mov_b32 v17, v16
    v_mov_b32 v18, v16
    s_nop 1
    v_permlane32_swap_b32 v17, v18
    s_nop 0
    v_max_f32 v16, v17, v18
    v_mul_f32 v17, s59, v16
    v_sub_f32 v18, v11, v17
    v_exp_f32 v18, v18
    v_mov_b32 v10, v16
    v_mov_b32 v11, v17
    s_nop 7
    v_mul_f32 v12, v12, v18
    v_mul_f32 v54, v54, v18
    v_mul_f32 v55, v55, v18
    v_mul_f32 v56, v56, v18
    v_mul_f32 v57, v57, v18
    s_nop 1
    s_branch A_NEXT0
A_RARE1:
    v_mov_b32 v16, v13
    s_nop 1
    v_max_f32_dpp v16, v16, v16 row_ror:4 row_mask:0xf bank_mask:0xf
    s_nop 1
    v_max_f32_dpp v16, v16, v16 row_ror:8 row_mask:0xf bank_mask:0xf
    v_mov_b32 v17, v16
    v_mov_b32 v18, v16
    s_nop 1
    v_permlane16_swap_b32 v17, v18
    s_nop 0
    v_max_f32 v16, v17, v18
    v_mov_b32 v17, v16
    v_mov_b32 v18, v16
    s_nop 1
    v_permlane32_swap_b32 v17, v18
    s_nop 0
    v_max_f32 v16, v17, v18
    v_mul_f32 v17, s59, v16
    v_sub_f32 v18, v11, v17
    v_exp_f32 v18, v18
    v_mov_b32 v10, v16
    v_mov_b32 v11, v17
    s_nop 7
    v_mul_f32 v12, v12, v18
    v_mul_f32 v54, v54, v18
    v_mul_f32 v55, v55, v18
    v_mul_f32 v56, v56, v18
    v_mul_f32 v57, v57, v18
    s_nop 1
    s_branch A_NEXT1
A_EXIT:
    s_waitcnt vmcnt(0) lgkmcnt(0)
    s_mov_b32 s76, 0
    s_cmp_lg_u32 s50, 0
    s_cbranch_scc1 A_NOWO
    s_mov_b32 s16, s32
    s_mov_b32 s17, s33
    s_mov_b32 s18, 0x400000
    s_mov_b32 s19, 0x00020000
    v_lshrrev_b32 v13, 3, v4
    v_lshl_or_b32 v13, v5, 1, v13
    v_lshlrev_b32 v13, 14, v13
    v_and_b32 v14, 7, v4
    v_lshl_or_b32 v13, v14, 4, v13
    s_lshl_b32 s53, s51, 17
    s_lshl_b32 s54, s52, 7
    s_add_u32 s53, s53, s54
    buffer_load_dwordx4 v[64:67], v13, s[16:19], s53 offen offset:0 nt
    buffer_load_dwordx4 v[68:71], v13, s[16:19], s53 offen offset:1024 nt
    buffer_load_dwordx4 v[72:75], v13, s[16:19], s53 offen offset:2048 nt
    buffer_load_dwordx4 v[76:79], v13, s[16:19], s53 offen offset:3072 nt
    s_add_u32 s53, s53, 4096
    buffer_load_dwordx4 v[80:83], v13, s[16:19], s53 offen offset:0 nt
    buffer_load_dwordx4 v[84:87], v13, s[16:19], s53 offen offset:1024 nt
    buffer_load_dwordx4 v[88:91], v13, s[16:19], s53 offen offset:2048 nt
    buffer_load_dwordx4 v[92:95], v13, s[16:19], s53 offen offset:3072 nt
    s_add_u32 s53, s53, 4096
    buffer_load_dwordx4 v[96:99], v13, s[16:19], s53 offen offset:0 nt
    buffer_load_dwordx4 v[100:103], v13, s[16:19], s53 offen offset:1024 nt
    buffer_load_dwordx4 v[104:107], v13, s[16:19], s53 offen offset:2048 nt
    buffer_load_dwordx4 v[108:111], v13, s[16:19], s53 offen offset:3072 nt
    s_add_u32 s53, s53, 4096
    buffer_load_dwordx4 v[112:115], v13, s[16:19], s53 offen offset:0 nt
    buffer_load_dwordx4 v[116:119], v13, s[16:19], s53 offen offset:1024 nt
    buffer_load_dwordx4 v[120:123], v13, s[16:19], s53 offen offset:2048 nt
    buffer_load_dwordx4 v[124:127], v13, s[16:19], s53 offen offset:3072 nt
A_NOWO:
    s_nop 1
    v_add_f32_dpp v12, v12, v12 row_ror:4 row_mask:0xf bank_mask:0xf
    s_nop 1
    v_add_f32_dpp v12, v12, v12 row_ror:8 row_mask:0xf bank_mask:0xf
    v_mov_b32 v13, v12
    v_mov_b32 v14, v12
    s_nop 1
    v_permlane16_swap_b32 v13, v14
    s_nop 0
    v_add_f32 v12, v13, v14
    v_mov_b32 v13, v12
    v_mov_b32 v14, v12
    s_nop 1
    v_permlane32_swap_b32 v13, v14
    s_nop 0
    v_add_f32 v12, v13, v14
    v_lshlrev_b32 v13, 5, v4
    v_lshl_or_b32 v13, v5, 4, v13
    s_lshl_b32 s53, s50, 9
    v_add_u32 v13, s53, v13
    s_lshl_b32 s53, s50, 3
    v_mov_b32 v14, s53
    s_mov_b32 exec_hi, 0
    ds_write_b128 v13, v[54:57] offset:2048
    s_mov_b64 exec, -1
    v_mov_b32 v16, v11
    v_mov_b32 v17, v12
    ds_write_b64 v14, v[16:17] offset:10240
    s_waitcnt lgkmcnt(0)
    s_barrier
    s_cmp_lg_u32 s50, 0
    s_cbranch_scc1 END
    v_mov_b32 v13, 0
    ds_read_b128 v[34:37], v13 offset:10240
    ds_read_b128 v[38:41], v13 offset:10256
    v_lshlrev_b32 v14, 3, v0
    ds_read_b64 v[42:43], v14 offset:2048
    ds_read_b64 v[44:45], v14 offset:2560
    ds_read_b64 v[46:47], v14 offset:3072
    ds_read_b64 v[48:49], v14 offset:3584
    s_waitcnt lgkmcnt(0)
    v_max3_f32 v11, v34, v36, v38
    v_max_f32 v11, v11, v40
    v_sub_f32 v34, v34, v11
    v_exp_f32 v34, v34
    v_sub_f32 v36, v36, v11
    v_exp_f32 v36, v36
    v_sub_f32 v38, v38, v11
    v_exp_f32 v38, v38
    v_sub_f32 v40, v40, v11
    v_exp_f32 v40, v40
    s_nop 0
    v_mul_f32 v12, v34, v35
    v_mul_f32 v50, v34, v42
    v_mul_f32 v52, v34, v43
    v_fmac_f32 v12, v36, v37
    v_fmac_f32 v50, v36, v44
    v_fmac_f32 v52, v36, v45
    v_fmac_f32 v12, v38, v39
    v_fmac_f32 v50, v38, v46
    v_fmac_f32 v52, v38, v47
    v_fmac_f32 v12, v40, v41
    v_fmac_f32 v50, v40, v48
    v_fmac_f32 v52, v40, v49
    v_mov_b32 v51, s55
    v_mov_b32 v53, s55
    v_mov_b32 v54, v11
    v_mov_b32 v55, s55
    v_mov_b32 v56, v12
    v_mov_b32 v57, s55
    s_lshl_b32 s53, s68, 11
    s_add_u32 s53, s53, 0x80000
    v_mov_b32 v16, 0x40000000
    v_cmp_eq_u32 vcc, 0, v0
    buffer_store_dwordx4 v[50:53], v2, s[12:15], s53 offen sc1
    s_nop 0
    v_cndmask_b32 v15, v16, 0, vcc
    buffer_store_dwordx4 v[54:57], v15, s[12:15], s53 offen offset:1024 sc1
    s_lshl_b32 s53, s51, 14
    s_add_u32 s53, s53, 0x80000
    s_add_u32 s54, s53, 8192
    v_and_b32 v13, 7, v0
    v_lshlrev_b32 v13, 11, v13
    s_nop 1
    v_add_u32 v14, 4096, v2
    buffer_load_dwordx4 v[22:25], v2, s[12:15], s53 offen offset:0 sc1
    buffer_load_dwordx4 v[26:29], v2, s[12:15], s53 offen offset:2048 sc1
    buffer_load_dwordx4 v[30:33], v14, s[12:15], s53 offen offset:0 sc1
    buffer_load_dwordx4 v[34:37], v14, s[12:15], s53 offen offset:2048 sc1
    buffer_load_dwordx4 v[38:41], v2, s[12:15], s54 offen offset:0 sc1
    buffer_load_dwordx4 v[42:45], v2, s[12:15], s54 offen offset:2048 sc1
    buffer_load_dwordx4 v[46:49], v14, s[12:15], s54 offen offset:0 sc1
    buffer_load_dwordx4 v[50:53], v14, s[12:15], s54 offen offset:2048 sc1
    buffer_load_dwordx4 v[54:57], v13, s[12:15], s53 offen offset:1024 sc1
    v_and_b32 v15, 1, v4
    v_cmp_eq_u32 vcc, 1, v15
    v_mov_b32 v16, 0x0c0c0100
    v_mov_b32 v17, 0x01000c0c
    v_cndmask_b32 v16, v16, v17, vcc
    v_mov_b32 v17, 0x0c0c0302
    v_mov_b32 v18, 0x03020c0c
    v_cndmask_b32 v17, v17, v18, vcc
    v_mov_b32 v18, 0x0c0c0c0c
    v_bfe_u32 v15, v4, 1, 2
    v_cmp_eq_u32 vcc, 0, v15
    s_nop 1
    v_cndmask_b32 v6, v18, v16, vcc
    v_cndmask_b32 v58, v18, v17, vcc
    v_cmp_eq_u32 vcc, 1, v15
    s_nop 1
    v_cndmask_b32 v7, v18, v16, vcc
    v_cndmask_b32 v59, v18, v17, vcc
    v_cmp_eq_u32 vcc, 2, v15
    s_nop 1
    v_cndmask_b32 v8, v18, v16, vcc
    v_cndmask_b32 v60, v18, v17, vcc
    v_cmp_eq_u32 vcc, 3, v15
    s_nop 1
    v_cndmask_b32 v9, v18, v16, vcc
    v_cndmask_b32 v61, v18, v17, vcc
    v_lshlrev_b32 v62, 2, v0
    v_lshrrev_b32 v15, 3, v4
    v_lshl_or_b32 v63, v5, 1, v15
    v_lshlrev_b32 v63, 5, v63
    v_and_b32 v10, 7, v4
    v_lshlrev_b32 v10, 7, v10
    v_and_b32 v16, 1, v5
    v_lshl_or_b32 v10, v16, 6, v10
    v_lshl_or_b32 v10, v15, 4, v10
    v_lshrrev_b32 v16, 1, v5
    v_cmp_eq_u32 vcc, v15, v16
    v_mov_b32 v16, 0x40000000
    s_lshl_b32 s72, s68, 10
    s_add_u32 s72, s72, 0x100000
    v_cndmask_b32 v10, v16, v10, vcc
A_P_POLL:
    s_waitcnt vmcnt(0)
    s_mov_b32 s69, 0
    v_cmp_ne_u32 vcc, s55, v23
    v_cmp_ne_u32 s[78:79], s55, v25
    s_or_b64 vcc, vcc, s[78:79]
    s_cbranch_vccz A_P_S0
    s_mov_b64 exec, vcc
    buffer_load_dwordx4 v[22:25], v2, s[12:15], s53 offen offset:0 sc1
    s_mov_b64 exec, -1
    s_mov_b32 s69, 1
A_P_S0:
    v_cmp_ne_u32 vcc, s55, v27
    v_cmp_ne_u32 s[78:79], s55, v29
    s_or_b64 vcc, vcc, s[78:79]
    s_cbranch_vccz A_P_S1
    s_mov_b64 exec, vcc
    buffer_load_dwordx4 v[26:29], v2, s[12:15], s53 offen offset:2048 sc1
    s_mov_b64 exec, -1
    s_mov_b32 s69, 1
A_P_S1:
    v_cmp_ne_u32 vcc, s55, v31
    v_cmp_ne_u32 s[78:79], s55, v33
    s_or_b64 vcc, vcc, s[78:79]
    s_cbranch_vccz A_P_S2
    s_mov_b64 exec, vcc
    buffer_load_dwordx4 v[30:33], v14, s[12:15], s53 offen offset:0 sc1
    s_mov_b64 exec, -1
    s_mov_b32 s69, 1
A_P_S2:
    v_cmp_ne_u32 vcc, s55, v35
    v_cmp_ne_u32 s[78:79], s55, v37
    s_or_b64 vcc, vcc, s[78:79]
    s_cbranch_vccz A_P_S3
    s_mov_b64 exec, vcc
    buffer_load_dwordx4 v[34:37], v14, s[12:15], s53 offen offset:2048 sc1
    s_mov_b64 exec, -1
    s_mov_b32 s69, 1
A_P_S3:
    v_cmp_ne_u32 vcc, s55, v39
    v_cmp_ne_u32 s[78:79], s55, v41
    s_or_b64 vcc, vcc, s[78:79]
    s_cbranch_vccz A_P_S4
    s_mov_b64 exec, vcc
    buffer_load_dwordx4 v[38:41], v2, s[12:15], s54 offen offset:0 sc1
    s_mov_b64 exec, -1
    s_mov_b32 s69, 1
A_P_S4:
    v_cmp_ne_u32 vcc, s55, v43
    v_cmp_ne_u32 s[78:79], s55, v45
    s_or_b64 vcc, vcc, s[78:79]
    s_cbranch_vccz A_P_S5
    s_mov_b64 exec, vcc
    buffer_load_dwordx4 v[42:45], v2, s[12:15], s54 offen offset:2048 sc1
    s_mov_b64 exec, -1
    s_mov_b32 s69, 1
A_P_S5:
    v_cmp_ne_u32 vcc, s55, v47
    v_cmp_ne_u32 s[78:79], s55, v49
    s_or_b64 vcc, vcc, s[78:79]
    s_cbranch_vccz A_P_S6
    s_mov_b64 exec, vcc
    buffer_load_dwordx4 v[46:49], v14, s[12:15], s54 offen offset:0 sc1
    s_mov_b64 exec, -1
    s_mov_b32 s69, 1
A_P_S6:
    v_cmp_ne_u32 vcc, s55, v51
    v_cmp_ne_u32 s[78:79], s55, v53
    s_or_b64 vcc, vcc, s[78:79]
    s_cbranch_vccz A_P_S7
    s_mov_b64 exec, vcc
    buffer_load_dwordx4 v[50:53], v14, s[12:15], s54 offen offset:2048 sc1
    s_mov_b64 exec, -1
    s_mov_b32 s69, 1
A_P_S7:
    v_cmp_ne_u32 vcc, s55, v55
    v_cmp_ne_u32 s[78:79], s55, v57
    s_or_b64 vcc, vcc, s[78:79]
    s_cbranch_vccz A_P_S8
    s_mov_b64 exec, vcc
    buffer_load_dwordx4 v[54:57], v13, s[12:15], s53 offen offset:1024 sc1
    s_mov_b64 exec, -1
    s_mov_b32 s69, 1
A_P_S8:
    s_cmp_eq_u32 s69, 0
    s_cbranch_scc1 A_P_DONE
    s_add_u32 s76, s76, 1
    s_and_b32 s78, s76, 63
    s_cmp_lg_u32 s78, 63
    s_cbranch_scc1 SPINR2
    s_waitcnt vmcnt(0)
    buffer_inv sc1
    s_waitcnt vmcnt(0)
SPINR2:
    s_cmp_gt_u32 s76, 0x40000
    s_cbranch_scc1 A_P_DONE
    s_sleep 1
    s_branch A_P_POLL
A_P_DONE:
    s_waitcnt vmcnt(0)
    v_max_f32_dpp v15, v54, v54 row_ror:1 row_mask:0xf bank_mask:0xf
    s_nop 1
    v_max_f32_dpp v15, v15, v15 row_ror:2 row_mask:0xf bank_mask:0xf
    s_nop 1
    v_max_f32_dpp v15, v15, v15 row_ror:4 row_mask:0xf bank_mask:0xf
    v_sub_f32 v16, v54, v15
    v_exp_f32 v16, v16
    v_mov_b32 v18, 0
    v_mul_f32 v17, v16, v56
    v_mov_b32 v19, 0
    v_fmac_f32_dpp v18, v16, v22 row_newbcast:0 row_mask:0xf bank_mask:0xf
    v_fmac_f32_dpp v19, v16, v24 row_newbcast:0 row_mask:0xf bank_mask:0xf
    v_add_f32_dpp v17, v17, v17 row_ror:1 row_mask:0xf bank_mask:0xf
    v_fmac_f32_dpp v18, v16, v26 row_newbcast:1 row_mask:0xf bank_mask:0xf
    v_fmac_f32_dpp v19, v16, v28 row_newbcast:1 row_mask:0xf bank_mask:0xf
    v_add_f32_dpp v17, v17, v17 row_ror:2 row_mask:0xf bank_mask:0xf
    v_fmac_f32_dpp v18, v16, v30 row_newbcast:2 row_mask:0xf bank_mask:0xf
    v_fmac_f32_dpp v19, v16, v32 row_newbcast:2 row_mask:0xf bank_mask:0xf
    v_add_f32_dpp v17, v17, v17 row_ror:4 row_mask:0xf bank_mask:0xf
    v_fmac_f32_dpp v18, v16, v34 row_newbcast:3 row_mask:0xf bank_mask:0xf
    v_fmac_f32_dpp v19, v16, v36 row_newbcast:3 row_mask:0xf bank_mask:0xf
    v_rcp_f32 v17, v17
    v_fmac_f32_dpp v18, v16, v38 row_newbcast:4 row_mask:0xf bank_mask:0xf
    v_fmac_f32_dpp v19, v16, v40 row_newbcast:4 row_mask:0xf bank_mask:0xf
    v_fmac_f32_dpp v18, v16, v42 row_newbcast:5 row_mask:0xf bank_mask:0xf
    v_fmac_f32_dpp v19, v16, v44 row_newbcast:5 row_mask:0xf bank_mask:0xf
    v_fmac_f32_dpp v18, v16, v46 row_newbcast:6 row_mask:0xf bank_mask:0xf
    v_fmac_f32_dpp v19, v16, v48 row_newbcast:6 row_mask:0xf bank_mask:0xf
    v_fmac_f32_dpp v18, v16, v50 row_newbcast:7 row_mask:0xf bank_mask:0xf
    v_fmac_f32_dpp v19, v16, v52 row_newbcast:7 row_mask:0xf bank_mask:0xf
    v_mul_f32 v18, v18, v17
    v_mul_f32 v19, v19, v17
    v_cvt_pk_bf16_f32 v18, v18, v19
    ds_write_b32 v62, v18 offset:10496
    ds_read_b128 v[34:37], v63 offset:10496
    ds_read_b128 v[38:41], v63 offset:10512
    v_mov_b32 v43, s55
    v_mov_b32 v45, s55
    v_mov_b32 v47, s55
    v_mov_b32 v49, s55
    s_waitcnt lgkmcnt(0)
    v_perm_b32 v22, v34, v34, v6
    v_perm_b32 v23, v34, v34, v7
    v_perm_b32 v24, v34, v34, v8
    v_perm_b32 v25, v34, v34, v9
    v_perm_b32 v26, v34, v34, v58
    v_perm_b32 v27, v34, v34, v59
    v_perm_b32 v28, v34, v34, v60
    v_perm_b32 v29, v34, v34, v61
    v_mfma_f32_16x16x32_bf16 v[54:57], v[22:25], v[64:67], 0
    v_perm_b32 v22, v35, v35, v6
    v_perm_b32 v23, v35, v35, v7
    v_perm_b32 v24, v35, v35, v8
    v_perm_b32 v25, v35, v35, v9
    v_mfma_f32_16x16x32_bf16 v[54:57], v[26:29], v[68:71], v[54:57]
    v_perm_b32 v26, v35, v35, v58
    v_perm_b32 v27, v35, v35, v59
    v_perm_b32 v28, v35, v35, v60
    v_perm_b32 v29, v35, v35, v61
    v_mfma_f32_16x16x32_bf16 v[54:57], v[22:25], v[72:75], v[54:57]
    v_perm_b32 v22, v36, v36, v6
    v_perm_b32 v23, v36, v36, v7
    v_perm_b32 v24, v36, v36, v8
    v_perm_b32 v25, v36, v36, v9
    v_mfma_f32_16x16x32_bf16 v[54:57], v[26:29], v[76:79], v[54:57]
    v_perm_b32 v26, v36, v36, v58
    v_perm_b32 v27, v36, v36, v59
    v_perm_b32 v28, v36, v36, v60
    v_perm_b32 v29, v36, v36, v61
    v_mfma_f32_16x16x32_bf16 v[54:57], v[22:25], v[80:83], v[54:57]
    v_perm_b32 v22, v37, v37, v6
    v_perm_b32 v23, v37, v37, v7
    v_perm_b32 v24, v37, v37, v8
    v_perm_b32 v25, v37, v37, v9
    v_mfma_f32_16x16x32_bf16 v[54:57], v[26:29], v[84:87], v[54:57]
    v_perm_b32 v26, v37, v37, v58
    v_perm_b32 v27, v37, v37, v59
    v_perm_b32 v28, v37, v37, v60
    v_perm_b32 v29, v37, v37, v61
    v_mfma_f32_16x16x32_bf16 v[54:57], v[22:25], v[88:91], v[54:57]
    v_perm_b32 v22, v38, v38, v6
    v_perm_b32 v23, v38, v38, v7
    v_perm_b32 v24, v38, v38, v8
    v_perm_b32 v25, v38, v38, v9
    v_mfma_f32_16x16x32_bf16 v[54:57], v[26:29], v[92:95], v[54:57]
    v_perm_b32 v26, v38, v38, v58
    v_perm_b32 v27, v38, v38, v59
    v_perm_b32 v28, v38, v38, v60
    v_perm_b32 v29, v38, v38, v61
    v_mfma_f32_16x16x32_bf16 v[54:57], v[22:25], v[96:99], v[54:57]
    v_perm_b32 v22, v39, v39, v6
    v_perm_b32 v23, v39, v39, v7
    v_perm_b32 v24, v39, v39, v8
    v_perm_b32 v25, v39, v39, v9
    v_mfma_f32_16x16x32_bf16 v[54:57], v[26:29], v[100:103], v[54:57]
    v_perm_b32 v26, v39, v39, v58
    v_perm_b32 v27, v39, v39, v59
    v_perm_b32 v28, v39, v39, v60
    v_perm_b32 v29, v39, v39, v61
    v_mfma_f32_16x16x32_bf16 v[54:57], v[22:25], v[104:107], v[54:57]
    v_perm_b32 v22, v40, v40, v6
    v_perm_b32 v23, v40, v40, v7
    v_perm_b32 v24, v40, v40, v8
    v_perm_b32 v25, v40, v40, v9
    v_mfma_f32_16x16x32_bf16 v[54:57], v[26:29], v[108:111], v[54:57]
    v_perm_b32 v26, v40, v40, v58
    v_perm_b32 v27, v40, v40, v59
    v_perm_b32 v28, v40, v40, v60
    v_perm_b32 v29, v40, v40, v61
    v_mfma_f32_16x16x32_bf16 v[54:57], v[22:25], v[112:115], v[54:57]
    v_perm_b32 v22, v41, v41, v6
    v_perm_b32 v23, v41, v41, v7
    v_perm_b32 v24, v41, v41, v8
    v_perm_b32 v25, v41, v41, v9
    v_mfma_f32_16x16x32_bf16 v[54:57], v[26:29], v[116:119], v[54:57]
    v_perm_b32 v26, v41, v41, v58
    v_perm_b32 v27, v41, v41, v59
    v_perm_b32 v28, v41, v41, v60
    v_perm_b32 v29, v41, v41, v61
    v_mfma_f32_16x16x32_bf16 v[54:57], v[22:25], v[120:123], v[54:57]
    s_nop 1
    v_mfma_f32_16x16x32_bf16 v[54:57], v[26:29], v[124:127], v[54:57]
    s_nop 7
    v_mov_b32 v42, v54
    v_mov_b32 v44, v55
    v_mov_b32 v46, v56
    v_mov_b32 v48, v57
    buffer_store_dwordx4 v[42:45], v10, s[12:15], s72 offen sc1
    buffer_store_dwordx4 v[46:49], v10, s[12:15], s72 offen offset:32 sc1
    s_cmp_ge_u32 s51, 4
    s_cbranch_scc1 A_FIN
    v_lshlrev_b32 v13, 13, v5
    v_lshl_or_b32 v13, v4, 4, v13
    s_lshl_b32 s53, s52, 10
    s_lshl_b32 s54, s51, 8
    s_add_u32 s53, s53, s54
    s_add_u32 s53, s53, 0x100000
    s_add_u32 s54, s53, 0x0
    buffer_load_dwordx4 v[64:67], v13, s[12:15], s54 offen sc1
    s_add_u32 s54, s53, 0x8000
    buffer_load_dwordx4 v[68:71], v13, s[12:15], s54 offen sc1
    s_add_u32 s54, s53, 0x10000
    buffer_load_dwordx4 v[72:75], v13, s[12:15], s54 offen sc1
    s_add_u32 s54, s53, 0x18000
    buffer_load_dwordx4 v[76:79], v13, s[12:15], s54 offen sc1
    s_add_u32 s54, s53, 0x20000
    buffer_load_dwordx4 v[80:83], v13, s[12:15], s54 offen sc1
    s_add_u32 s54, s53, 0x28000
    buffer_load_dwordx4 v[84:87], v13, s[12:15], s54 offen sc1
    s_add_u32 s54, s53, 0x30000
    buffer_load_dwordx4 v[88:91], v13, s[12:15], s54 offen sc1
    s_add_u32 s54, s53, 0x38000
    buffer_load_dwordx4 v[92:95], v13, s[12:15], s54 offen sc1
    v_mov_b32 v14, 0
    buffer_load_dword v20, v14, s[20:23], 0 offen offset:4 sc1
    s_mov_b32 s16, s44
    s_mov_b32 s17, s45
    s_mov_b32 s18, 0x800
    s_mov_b32 s19, 0x00020000
    v_and_b32 v14, 0x31, v0
    v_cmp_eq_u32 vcc, 0, v14
    v_mov_b32 v16, 0x40000000
    v_lshlrev_b32 v19, 1, v0
    s_lshl_b32 s72, s52, 7
    s_lshl_b32 s73, s51, 5
    s_add_u32 s72, s72, s73
    v_cndmask_b32 v19, v16, v19, vcc
A_Y_POLL:
    s_waitcnt vmcnt(0)
    s_mov_b32 s69, 0
    s_add_u32 s54, s53, 0x0
    v_cmp_ne_u32 vcc, s55, v65
    v_cmp_ne_u32 s[78:79], s55, v67
    s_or_b64 vcc, vcc, s[78:79]
    s_cbranch_vccz A_Y_S0
    s_mov_b64 exec, vcc
    buffer_load_dwordx4 v[64:67], v13, s[12:15], s54 offen sc1
    s_mov_b64 exec, -1
    s_mov_b32 s69, 1
A_Y_S0:
    s_add_u32 s54, s53, 0x8000
    v_cmp_ne_u32 vcc, s55, v69
    v_cmp_ne_u32 s[78:79], s55, v71
    s_or_b64 vcc, vcc, s[78:79]
    s_cbranch_vccz A_Y_S1
    s_mov_b64 exec, vcc
    buffer_load_dwordx4 v[68:71], v13, s[12:15], s54 offen sc1
    s_mov_b64 exec, -1
    s_mov_b32 s69, 1
A_Y_S1:
    s_add_u32 s54, s53, 0x10000
    v_cmp_ne_u32 vcc, s55, v73
    v_cmp_ne_u32 s[78:79], s55, v75
    s_or_b64 vcc, vcc, s[78:79]
    s_cbranch_vccz A_Y_S2
    s_mov_b64 exec, vcc
    buffer_load_dwordx4 v[72:75], v13, s[12:15], s54 offen sc1
    s_mov_b64 exec, -1
    s_mov_b32 s69, 1
A_Y_S2:
    s_add_u32 s54, s53, 0x18000
    v_cmp_ne_u32 vcc, s55, v77
    v_cmp_ne_u32 s[78:79], s55, v79
    s_or_b64 vcc, vcc, s[78:79]
    s_cbranch_vccz A_Y_S3
    s_mov_b64 exec, vcc
    buffer_load_dwordx4 v[76:79], v13, s[12:15], s54 offen sc1
    s_mov_b64 exec, -1
    s_mov_b32 s69, 1
A_Y_S3:
    s_add_u32 s54, s53, 0x20000
    v_cmp_ne_u32 vcc, s55, v81
    v_cmp_ne_u32 s[78:79], s55, v83
    s_or_b64 vcc, vcc, s[78:79]
    s_cbranch_vccz A_Y_S4
    s_mov_b64 exec, vcc
    buffer_load_dwordx4 v[80:83], v13, s[12:15], s54 offen sc1
    s_mov_b64 exec, -1
    s_mov_b32 s69, 1
A_Y_S4:
    s_add_u32 s54, s53, 0x28000
    v_cmp_ne_u32 vcc, s55, v85
    v_cmp_ne_u32 s[78:79], s55, v87
    s_or_b64 vcc, vcc, s[78:79]
    s_cbranch_vccz A_Y_S5
    s_mov_b64 exec, vcc
    buffer_load_dwordx4 v[84:87], v13, s[12:15], s54 offen sc1
    s_mov_b64 exec, -1
    s_mov_b32 s69, 1
A_Y_S5:
    s_add_u32 s54, s53, 0x30000
    v_cmp_ne_u32 vcc, s55, v89
    v_cmp_ne_u32 s[78:79], s55, v91
    s_or_b64 vcc, vcc, s[78:79]
    s_cbranch_vccz A_Y_S6
    s_mov_b64 exec, vcc
    buffer_load_dwordx4 v[88:91], v13, s[12:15], s54 offen sc1
    s_mov_b64 exec, -1
    s_mov_b32 s69, 1
A_Y_S6:
    s_add_u32 s54, s53, 0x38000
    v_cmp_ne_u32 vcc, s55, v93
    v_cmp_ne_u32 s[78:79], s55, v95
    s_or_b64 vcc, vcc, s[78:79]
    s_cbranch_vccz A_Y_S7
    s_mov_b64 exec, vcc
    buffer_load_dwordx4 v[92:95], v13, s[12:15], s54 offen sc1
    s_mov_b64 exec, -1
    s_mov_b32 s69, 1
A_Y_S7:
    s_cmp_eq_u32 s69, 0
    s_cbranch_scc1 A_Y_DONE
    s_add_u32 s76, s76, 1
    s_and_b32 s78, s76, 63
    s_cmp_lg_u32 s78, 63
    s_cbranch_scc1 SPINR3
    s_waitcnt vmcnt(0)
    buffer_inv sc1
    s_waitcnt vmcnt(0)
SPINR3:
    s_cmp_gt_u32 s76, 0x40000
    s_cbranch_scc1 A_Y_DONE
    s_sleep 1
    s_branch A_Y_POLL
A_Y_DONE:
    s_waitcnt vmcnt(0)
    v_add_f32 v64, v64, v68
    v_add_f32 v66, v66, v70
    v_add_f32 v64, v64, v72
    v_add_f32 v66, v66, v74
    v_add_f32 v64, v64, v76
    v_add_f32 v66, v66, v78
    v_add_f32 v64, v64, v80
    v_add_f32 v66, v66, v82
    v_add_f32 v64, v64, v84
    v_add_f32 v66, v66, v86
    v_add_f32 v64, v64, v88
    v_add_f32 v66, v66, v90
    v_add_f32 v64, v64, v92
    v_add_f32 v66, v66, v94
    s_nop 0
    v_add_f32_dpp v64, v64, v64 quad_perm:[1,0,3,2] row_mask:0xf bank_mask:0xf
    v_add_f32_dpp v66, v66, v66 quad_perm:[1,0,3,2] row_mask:0xf bank_mask:0xf
    v_mov_b32 v15, v64
    v_mov_b32 v17, v66
    s_nop 0
    v_permlane16_swap_b32 v15, v64
    v_permlane16_swap_b32 v17, v66
    v_add_f32 v64, v15, v64
    v_add_f32 v66, v17, v66
    v_mov_b32 v15, v64
    v_mov_b32 v17, v66
    s_nop 0
    v_permlane32_swap_b32 v15, v64
    v_permlane32_swap_b32 v17, v66
    v_add_f32 v64, v15, v64
    v_add_f32 v66, v17, v66
    v_cvt_pk_bf16_f32 v64, v64, v66
    buffer_store_dword v64, v19, s[16:19], s72 offen
    s_cmp_lg_u32 s68, 0
    s_cbranch_scc1 A_FIN
    v_readfirstlane_b32 s53, v20
    s_cmp_lg_u32 s53, s55
    s_cbranch_scc1 A_FIN
    v_mov_b32 v15, 0
    v_lshlrev_b32 v17, 2, v0
    v_mov_b32 v16, 0x40000000
    v_cmp_gt_u32 vcc, 2, v0
    s_nop 1
    v_cndmask_b32 v17, v16, v17, vcc
    buffer_store_dword v15, v17, s[20:23], 0 offen sc1
A_FIN:
    s_branch END
B_PATH:
    v_and_b32 v13, 1, v4
    v_cmp_eq_u32 vcc, 1, v13
    v_mov_b32 v14, 0xffff
    v_mov_b32 v15, 0xffff0000
    v_cndmask_b32 v14, v14, v15, vcc
    v_lshrrev_b32 v13, 1, v4
    v_cmp_eq_u32 vcc, 0, v13
    s_nop 1
    v_cndmask_b32 v6, 0, v14, vcc
    v_cmp_eq_u32 vcc, 1, v13
    s_nop 1
    v_cndmask_b32 v7, 0, v14, vcc
    v_cmp_eq_u32 vcc, 2, v13
    s_nop 1
    v_cndmask_b32 v8, 0, v14, vcc
    v_cmp_eq_u32 vcc, 3, v13
    s_nop 1
    v_cndmask_b32 v9, 0, v14, vcc
    s_mov_b32 s58, 0x3db504f3
    s_mov_b32 s59, 0x3fb8aa3b
    s_mov_b32 s76, 0
    s_mov_b32 s74, 0x01000100
    s_mov_b32 s75, 0x03020302
    v_mov_b32 v10, 0xff800000
    v_mov_b32 v11, 0xff800000
    v_mov_b32 v12, 0
    s_lshr_b32 s51, s2, 2
    s_and_b32 s52, s2, 3
    s_lshl_b32 s53, s51, 23
    s_lshl_b32 s54, s52, 18
    s_add_u32 s53, s53, s54
    s_add_u32 s53, s53, 0x700000
    s_add_u32 s4, s36, s53
    s_addc_u32 s5, s37, 0
    s_mov_b32 s6, 0x40000
    s_mov_b32 s7, 0x00020000
    s_add_u32 s8, s38, s53
    s_addc_u32 s9, s39, 0
    s_mov_b32 s10, 0x40000
    s_mov_b32 s11, 0x00020000
    s_cmp_lg_u32 s50, 0
    s_cbranch_scc1 B_NONONCE
    v_mov_b32 v13, 0
    buffer_load_dword v20, v13, s[20:23], 0 offen sc1
NONCE_B:
    s_waitcnt vmcnt(0)
    v_readfirstlane_b32 s55, v20
    s_cmp_lg_u32 s55, 0
    s_cbranch_scc1 NONCE_OK_B
    s_add_u32 s76, s76, 1
    s_and_b32 s78, s76, 63
    s_cmp_lg_u32 s78, 63
    s_cbranch_scc1 SPINR4
    s_waitcnt vmcnt(0)
    buffer_inv sc1
    s_waitcnt vmcnt(0)
SPINR4:
    s_cmp_gt_u32 s76, 0x40000
    s_cbranch_scc1 NONCE_OK_B
    s_sleep 1
    v_mov_b32 v13, 0
    buffer_load_dword v20, v13, s[20:23], 0 offen sc1
    s_branch NONCE_B
NONCE_OK_B:
    s_lshl_b32 s53, s2, 13
    s_add_u32 s53, s53, 0x10000
    v_and_b32 v13, 7, v0
    v_lshlrev_b32 v13, 10, v13
B_WPOLL:
    buffer_load_dwordx2 v[34:35], v13, s[12:15], s53 offen sc1
    s_waitcnt vmcnt(0)
    v_cmp_ne_u32 vcc, s55, v35
    s_cbranch_vccz B_WDONE
    s_add_u32 s76, s76, 1
    s_and_b32 s78, s76, 63
    s_cmp_lg_u32 s78, 63
    s_cbranch_scc1 SPINR5
    s_waitcnt vmcnt(0)
    buffer_inv sc1
    s_waitcnt vmcnt(0)
SPINR5:
    s_cmp_gt_u32 s76, 0x40000
    s_cbranch_scc1 B_WDONE
    s_sleep 8
    s_branch B_WPOLL
B_WDONE:
B_NONONCE:
    s_barrier
    s_mov_b32 s16, s34
    s_mov_b32 s17, s35
    s_mov_b32 s18, 0x400
    s_mov_b32 s19, 0x00020000
    v_lshrrev_b32 v13, 2, v4
    v_lshlrev_b32 v13, 4, v13
    v_lshl_or_b32 v13, v5, 6, v13
    s_lshl_b32 s53, s50, 8
    buffer_load_dwordx4 v[34:37], v13, s[16:19], s53 offen
    s_nop 0
    s_mov_b32 s16, s40
    s_mov_b32 s17, s41
    s_mov_b32 s18, 0x400000
    s_mov_b32 s19, 0x00020000
    v_lshlrev_b32 v14, 18, v5
    v_lshl_or_b32 v14, v4, 4, v14
    s_lshl_b32 s53, s50, 20
    s_lshl_b32 s54, s2, 8
    s_add_u32 s53, s53, s54
    s_add_u32 s54, s53, 0x0
    buffer_load_dwordx4 v[64:67], v14, s[16:19], s54 offen nt
    s_add_u32 s54, s53, 0x10000
    buffer_load_dwordx4 v[68:71], v14, s[16:19], s54 offen nt
    s_add_u32 s54, s53, 0x20000
    buffer_load_dwordx4 v[72:75], v14, s[16:19], s54 offen nt
    s_add_u32 s54, s53, 0x30000
    buffer_load_dwordx4 v[76:79], v14, s[16:19], s54 offen nt
    s_add_u32 s54, s53, 0x2000
    buffer_load_dwordx4 v[80:83], v14, s[16:19], s54 offen nt
    s_add_u32 s54, s53, 0x12000
    buffer_load_dwordx4 v[84:87], v14, s[16:19], s54 offen nt
    s_add_u32 s54, s53, 0x22000
    buffer_load_dwordx4 v[88:91], v14, s[16:19], s54 offen nt
    s_add_u32 s54, s53, 0x32000
    buffer_load_dwordx4 v[92:95], v14, s[16:19], s54 offen nt
    s_add_u32 s54, s53, 0x4000
    buffer_load_dwordx4 v[96:99], v14, s[16:19], s54 offen nt
    s_add_u32 s54, s53, 0x14000
    buffer_load_dwordx4 v[100:103], v14, s[16:19], s54 offen nt
    s_add_u32 s54, s53, 0x24000
    buffer_load_dwordx4 v[104:107], v14, s[16:19], s54 offen nt
    s_add_u32 s54, s53, 0x34000
    buffer_load_dwordx4 v[108:111], v14, s[16:19], s54 offen nt
    s_add_u32 s54, s53, 0x6000
    buffer_load_dwordx4 v[112:115], v14, s[16:19], s54 offen nt
    s_add_u32 s54, s53, 0x16000
    buffer_load_dwordx4 v[116:119], v14, s[16:19], s54 offen nt
    s_add_u32 s54, s53, 0x26000
    buffer_load_dwordx4 v[120:123], v14, s[16:19], s54 offen nt
    s_add_u32 s54, s53, 0x36000
    buffer_load_dwordx4 v[124:127], v14, s[16:19], s54 offen nt
    s_waitcnt vmcnt(16)
    v_perm_b32 v38, v34, v34, s74
    v_perm_b32 v39, v34, v34, s75
    v_perm_b32 v40, v35, v35, s74
    v_perm_b32 v41, v35, v35, s75
    v_perm_b32 v42, v36, v36, s74
    v_perm_b32 v43, v36, v36, s75
    v_perm_b32 v44, v37, v37, s74
    v_perm_b32 v45, v37, v37, s75
    s_nop 1
    v_and_b32_dpp v22, v38, v6 row_newbcast:0 row_mask:0xf bank_mask:0xf
    v_and_b32_dpp v23, v38, v7 row_newbcast:0 row_mask:0xf bank_mask:0xf
    v_and_b32_dpp v24, v38, v8 row_newbcast:0 row_mask:0xf bank_mask:0xf
    v_and_b32_dpp v25, v38, v9 row_newbcast:0 row_mask:0xf bank_mask:0xf
    s_waitcnt vmcnt(15)
    s_nop 0
    v_mfma_f32_16x16x32_bf16 v[54:57], v[22:25], v[64:67], 0
    v_and_b32_dpp v26, v38, v6 row_newbcast:4 row_mask:0xf bank_mask:0xf
    v_and_b32_dpp v27, v38, v7 row_newbcast:4 row_mask:0xf bank_mask:0xf
    v_and_b32_dpp v28, v38, v8 row_newbcast:4 row_mask:0xf bank_mask:0xf
    v_and_b32_dpp v29, v38, v9 row_newbcast:4 row_mask:0xf bank_mask:0xf
    s_waitcnt vmcnt(14)
    s_nop 0
    v_mfma_f32_16x16x32_bf16 v[54:57], v[26:29], v[68:71], v[54:57]
    v_and_b32_dpp v22, v38, v6 row_newbcast:8 row_mask:0xf bank_mask:0xf
    v_and_b32_dpp v23, v38, v7 row_newbcast:8 row_mask:0xf bank_mask:0xf
    v_and_b32_dpp v24, v38, v8 row_newbcast:8 row_mask:0xf bank_mask:0xf
    v_and_b32_dpp v25, v38, v9 row_newbcast:8 row_mask:0xf bank_mask:0xf
    s_waitcnt vmcnt(13)
    s_nop 0
    v_mfma_f32_16x16x32_bf16 v[54:57], v[22:25], v[72:75], v[54:57]
    v_and_b32_dpp v26, v38, v6 row_newbcast:12 row_mask:0xf bank_mask:0xf
    v_and_b32_dpp v27, v38, v7 row_newbcast:12 row_mask:0xf bank_mask:0xf
    v_and_b32_dpp v28, v38, v8 row_newbcast:12 row_mask:0xf bank_mask:0xf
    v_and_b32_dpp v29, v38, v9 row_newbcast:12 row_mask:0xf bank_mask:0xf
    s_waitcnt vmcnt(12)
    s_nop 0
    v_mfma_f32_16x16x32_bf16 v[54:57], v[26:29], v[76:79], v[54:57]
    v_and_b32_dpp v22, v39, v6 row_newbcast:0 row_mask:0xf bank_mask:0xf
    v_and_b32_dpp v23, v39, v7 row_newbcast:0 row_mask:0xf bank_mask:0xf
    v_and_b32_dpp v24, v39, v8 row_newbcast:0 row_mask:0xf bank_mask:0xf
    v_and_b32_dpp v25, v39, v9 row_newbcast:0 row_mask:0xf bank_mask:0xf
    s_waitcnt vmcnt(11)
    s_nop 0
    v_mfma_f32_16x16x32_bf16 v[54:57], v[22:25], v[80:83], v[54:57]
    v_and_b32_dpp v26, v39, v6 row_newbcast:4 row_mask:0xf bank_mask:0xf
    v_and_b32_dpp v27, v39, v7 row_newbcast:4 row_mask:0xf bank_mask:0xf
    v_and_b32_dpp v28, v39, v8 row_newbcast:4 row_mask:0xf bank_mask:0xf
    v_and_b32_dpp v29, v39, v9 row_newbcast:4 row_mask:0xf bank_mask:0xf
    s_waitcnt vmcnt(10)
    s_nop 0
    v_mfma_f32_16x16x32_bf16 v[54:57], v[26:29], v[84:87], v[54:57]
    v_and_b32_dpp v22, v39, v6 row_newbcast:8 row_mask:0xf bank_mask:0xf
    v_and_b32_dpp v23, v39, v7 row_newbcast:8 row_mask:0xf bank_mask:0xf
    v_and_b32_dpp v24, v39, v8 row_newbcast:8 row_mask:0xf bank_mask:0xf
    v_and_b32_dpp v25, v39, v9 row_newbcast:8 row_mask:0xf bank_mask:0xf
    s_waitcnt vmcnt(9)
    s_nop 0
    v_mfma_f32_16x16x32_bf16 v[54:57], v[22:25], v[88:91], v[54:57]
    v_and_b32_dpp v26, v39, v6 row_newbcast:12 row_mask:0xf bank_mask:0xf
    v_and_b32_dpp v27, v39, v7 row_newbcast:12 row_mask:0xf bank_mask:0xf
    v_and_b32_dpp v28, v39, v8 row_newbcast:12 row_mask:0xf bank_mask:0xf
    v_and_b32_dpp v29, v39, v9 row_newbcast:12 row_mask:0xf bank_mask:0xf
    s_waitcnt vmcnt(8)
    s_nop 0
    v_mfma_f32_16x16x32_bf16 v[54:57], v[26:29], v[92:95], v[54:57]
    v_and_b32_dpp v22, v40, v6 row_newbcast:0 row_mask:0xf bank_mask:0xf
    v_and_b32_dpp v23, v40, v7 row_newbcast:0 row_mask:0xf bank_mask:0xf
    v_and_b32_dpp v24, v40, v8 row_newbcast:0 row_mask:0xf bank_mask:0xf
    v_and_b32_dpp v25, v40, v9 row_newbcast:0 row_mask:0xf bank_mask:0xf
    s_waitcnt vmcnt(7)
    s_nop 0
    v_mfma_f32_16x16x32_bf16 v[54:57], v[22:25], v[96:99], v[54:57]
    v_and_b32_dpp v26, v40, v6 row_newbcast:4 row_mask:0xf bank_mask:0xf
    v_and_b32_dpp v27, v40, v7 row_newbcast:4 row_mask:0xf bank_mask:0xf
    v_and_b32_dpp v28, v40, v8 row_newbcast:4 row_mask:0xf bank_mask:0xf
    v_and_b32_dpp v29, v40, v9 row_newbcast:4 row_mask:0xf bank_mask:0xf
    s_waitcnt vmcnt(6)
    s_nop 0
    v_mfma_f32_16x16x32_bf16 v[54:57], v[26:29], v[100:103], v[54:57]
    v_and_b32_dpp v22, v40, v6 row_newbcast:8 row_mask:0xf bank_mask:0xf
    v_and_b32_dpp v23, v40, v7 row_newbcast:8 row_mask:0xf bank_mask:0xf
    v_and_b32_dpp v24, v40, v8 row_newbcast:8 row_mask:0xf bank_mask:0xf
    v_and_b32_dpp v25, v40, v9 row_newbcast:8 row_mask:0xf bank_mask:0xf
    s_waitcnt vmcnt(5)
    s_nop 0
    v_mfma_f32_16x16x32_bf16 v[54:57], v[22:25], v[104:107], v[54:57]
    v_and_b32_dpp v26, v40, v6 row_newbcast:12 row_mask:0xf bank_mask:0xf
    v_and_b32_dpp v27, v40, v7 row_newbcast:12 row_mask:0xf bank_mask:0xf
    v_and_b32_dpp v28, v40, v8 row_newbcast:12 row_mask:0xf bank_mask:0xf
    v_and_b32_dpp v29, v40, v9 row_newbcast:12 row_mask:0xf bank_mask:0xf
    s_waitcnt vmcnt(4)
    s_nop 0
    v_mfma_f32_16x16x32_bf16 v[54:57], v[26:29], v[108:111], v[54:57]
    v_and_b32_dpp v22, v41, v6 row_newbcast:0 row_mask:0xf bank_mask:0xf
    v_and_b32_dpp v23, v41, v7 row_newbcast:0 row_mask:0xf bank_mask:0xf
    v_and_b32_dpp v24, v41, v8 row_newbcast:0 row_mask:0xf bank_mask:0xf
    v_and_b32_dpp v25, v41, v9 row_newbcast:0 row_mask:0xf bank_mask:0xf
    s_waitcnt vmcnt(3)
    s_nop 0
    v_mfma_f32_16x16x32_bf16 v[54:57], v[22:25], v[112:115], v[54:57]
    v_and_b32_dpp v26, v41, v6 row_newbcast:4 row_mask:0xf bank_mask:0xf
    v_and_b32_dpp v27, v41, v7 row_newbcast:4 row_mask:0xf bank_mask:0xf
    v_and_b32_dpp v28, v41, v8 row_newbcast:4 row_mask:0xf bank_mask:0xf
    v_and_b32_dpp v29, v41, v9 row_newbcast:4 row_mask:0xf bank_mask:0xf
    s_waitcnt vmcnt(2)
    s_nop 0
    v_mfma_f32_16x16x32_bf16 v[54:57], v[26:29], v[116:119], v[54:57]
    v_and_b32_dpp v22, v41, v6 row_newbcast:8 row_mask:0xf bank_mask:0xf
    v_and_b32_dpp v23, v41, v7 row_newbcast:8 row_mask:0xf bank_mask:0xf
    v_and_b32_dpp v24, v41, v8 row_newbcast:8 row_mask:0xf bank_mask:0xf
    v_and_b32_dpp v25, v41, v9 row_newbcast:8 row_mask:0xf bank_mask:0xf
    s_waitcnt vmcnt(1)
    s_nop 0
    v_mfma_f32_16x16x32_bf16 v[54:57], v[22:25], v[120:123], v[54:57]
    v_and_b32_dpp v26, v41, v6 row_newbcast:12 row_mask:0xf bank_mask:0xf
    v_and_b32_dpp v27, v41, v7 row_newbcast:12 row_mask:0xf bank_mask:0xf
    v_and_b32_dpp v28, v41, v8 row_newbcast:12 row_mask:0xf bank_mask:0xf
    v_and_b32_dpp v29, v41, v9 row_newbcast:12 row_mask:0xf bank_mask:0xf
    s_waitcnt vmcnt(0)
    s_nop 0
    v_mfma_f32_16x16x32_bf16 v[54:57], v[26:29], v[124:127], v[54:57]
    s_add_u32 s54, s53, 0x8000
    buffer_load_dwordx4 v[64:67], v14, s[16:19], s54 offen nt
    s_add_u32 s54, s53, 0x18000
    buffer_load_dwordx4 v[68:71], v14, s[16:19], s54 offen nt
    s_add_u32 s54, s53, 0x28000
    buffer_load_dwordx4 v[72:75], v14, s[16:19], s54 offen nt
    s_add_u32 s54, s53, 0x38000
    buffer_load_dwordx4 v[76:79], v14, s[16:19], s54 offen nt
    s_add_u32 s54, s53, 0xa000
    buffer_load_dwordx4 v[80:83], v14, s[16:19], s54 offen nt
    s_add_u32 s54, s53, 0x1a000
    buffer_load_dwordx4 v[84:87], v14, s[16:19], s54 offen nt
    s_add_u32 s54, s53, 0x2a000
    buffer_load_dwordx4 v[88:91], v14, s[16:19], s54 offen nt
    s_add_u32 s54, s53, 0x3a000
    buffer_load_dwordx4 v[92:95], v14, s[16:19], s54 offen nt
    s_add_u32 s54, s53, 0xc000
    buffer_load_dwordx4 v[96:99], v14, s[16:19], s54 offen nt
    s_add_u32 s54, s53, 0x1c000
    buffer_load_dwordx4 v[100:103], v14, s[16:19], s54 offen nt
    s_add_u32 s54, s53, 0x2c000
    buffer_load_dwordx4 v[104:107], v14, s[16:19], s54 offen nt
    s_add_u32 s54, s53, 0x3c000
    buffer_load_dwordx4 v[108:111], v14, s[16:19], s54 offen nt
    s_add_u32 s54, s53, 0xe000
    buffer_load_dwordx4 v[112:115], v14, s[16:19], s54 offen nt
    s_add_u32 s54, s53, 0x1e000
    buffer_load_dwordx4 v[116:119], v14, s[16:19], s54 offen nt
    s_add_u32 s54, s53, 0x2e000
    buffer_load_dwordx4 v[120:123], v14, s[16:19], s54 offen nt
    s_add_u32 s54, s53, 0x3e000
    buffer_load_dwordx4 v[124:127], v14, s[16:19], s54 offen nt
    v_and_b32_dpp v22, v42, v6 row_newbcast:0 row_mask:0xf bank_mask:0xf
    v_and_b32_dpp v23, v42, v7 row_newbcast:0 row_mask:0xf bank_mask:0xf
    v_and_b32_dpp v24, v42, v8 row_newbcast:0 row_mask:0xf bank_mask:0xf
    v_and_b32_dpp v25, v42, v9 row_newbcast:0 row_mask:0xf bank_mask:0xf
    s_waitcnt vmcnt(15)
    s_nop 0
    v_mfma_f32_16x16x32_bf16 v[54:57], v[22:25], v[64:67], v[54:57]
    v_and_b32_dpp v26, v42, v6 row_newbcast:4 row_mask:0xf bank_mask:0xf
    v_and_b32_dpp v27, v42, v7 row_newbcast:4 row_mask:0xf bank_mask:0xf
    v_and_b32_dpp v28, v42, v8 row_newbcast:4 row_mask:0xf bank_mask:0xf
    v_and_b32_dpp v29, v42, v9 row_newbcast:4 row_mask:0xf bank_mask:0xf
    s_waitcnt vmcnt(14)
    s_nop 0
    v_mfma_f32_16x16x32_bf16 v[54:57], v[26:29], v[68:71], v[54:57]
    v_and_b32_dpp v22, v42, v6 row_newbcast:8 row_mask:0xf bank_mask:0xf
    v_and_b32_dpp v23, v42, v7 row_newbcast:8 row_mask:0xf bank_mask:0xf
    v_and_b32_dpp v24, v42, v8 row_newbcast:8 row_mask:0xf bank_mask:0xf
    v_and_b32_dpp v25, v42, v9 row_newbcast:8 row_mask:0xf bank_mask:0xf
    s_waitcnt vmcnt(13)
    s_nop 0
    v_mfma_f32_16x16x32_bf16 v[54:57], v[22:25], v[72:75], v[54:57]
    v_and_b32_dpp v26, v42, v6 row_newbcast:12 row_mask:0xf bank_mask:0xf
    v_and_b32_dpp v27, v42, v7 row_newbcast:12 row_mask:0xf bank_mask:0xf
    v_and_b32_dpp v28, v42, v8 row_newbcast:12 row_mask:0xf bank_mask:0xf
    v_and_b32_dpp v29, v42, v9 row_newbcast:12 row_mask:0xf bank_mask:0xf
    s_waitcnt vmcnt(12)
    s_nop 0
    v_mfma_f32_16x16x32_bf16 v[54:57], v[26:29], v[76:79], v[54:57]
    v_and_b32_dpp v22, v43, v6 row_newbcast:0 row_mask:0xf bank_mask:0xf
    v_and_b32_dpp v23, v43, v7 row_newbcast:0 row_mask:0xf bank_mask:0xf
    v_and_b32_dpp v24, v43, v8 row_newbcast:0 row_mask:0xf bank_mask:0xf
    v_and_b32_dpp v25, v43, v9 row_newbcast:0 row_mask:0xf bank_mask:0xf
    s_waitcnt vmcnt(11)
    s_nop 0
    v_mfma_f32_16x16x32_bf16 v[54:57], v[22:25], v[80:83], v[54:57]
    v_and_b32_dpp v26, v43, v6 row_newbcast:4 row_mask:0xf bank_mask:0xf
    v_and_b32_dpp v27, v43, v7 row_newbcast:4 row_mask:0xf bank_mask:0xf
    v_and_b32_dpp v28, v43, v8 row_newbcast:4 row_mask:0xf bank_mask:0xf
    v_and_b32_dpp v29, v43, v9 row_newbcast:4 row_mask:0xf bank_mask:0xf
    s_waitcnt vmcnt(10)
    s_nop 0
    v_mfma_f32_16x16x32_bf16 v[54:57], v[26:29], v[84:87], v[54:57]
    v_and_b32_dpp v22, v43, v6 row_newbcast:8 row_mask:0xf bank_mask:0xf
    v_and_b32_dpp v23, v43, v7 row_newbcast:8 row_mask:0xf bank_mask:0xf
    v_and_b32_dpp v24, v43, v8 row_newbcast:8 row_mask:0xf bank_mask:0xf
    v_and_b32_dpp v25, v43, v9 row_newbcast:8 row_mask:0xf bank_mask:0xf
    s_waitcnt vmcnt(9)
    s_nop 0
    v_mfma_f32_16x16x32_bf16 v[54:57], v[22:25], v[88:91], v[54:57]
    v_and_b32_dpp v26, v43, v6 row_newbcast:12 row_mask:0xf bank_mask:0xf
    v_and_b32_dpp v27, v43, v7 row_newbcast:12 row_mask:0xf bank_mask:0xf
    v_and_b32_dpp v28, v43, v8 row_newbcast:12 row_mask:0xf bank_mask:0xf
    v_and_b32_dpp v29, v43, v9 row_newbcast:12 row_mask:0xf bank_mask:0xf
    s_waitcnt vmcnt(8)
    s_nop 0
    v_mfma_f32_16x16x32_bf16 v[54:57], v[26:29], v[92:95], v[54:57]
    v_and_b32_dpp v22, v44, v6 row_newbcast:0 row_mask:0xf bank_mask:0xf
    v_and_b32_dpp v23, v44, v7 row_newbcast:0 row_mask:0xf bank_mask:0xf
    v_and_b32_dpp v24, v44, v8 row_newbcast:0 row_mask:0xf bank_mask:0xf
    v_and_b32_dpp v25, v44, v9 row_newbcast:0 row_mask:0xf bank_mask:0xf
    s_waitcnt vmcnt(7)
    s_nop 0
    v_mfma_f32_16x16x32_bf16 v[54:57], v[22:25], v[96:99], v[54:57]
    v_and_b32_dpp v26, v44, v6 row_newbcast:4 row_mask:0xf bank_mask:0xf
    v_and_b32_dpp v27, v44, v7 row_newbcast:4 row_mask:0xf bank_mask:0xf
    v_and_b32_dpp v28, v44, v8 row_newbcast:4 row_mask:0xf bank_mask:0xf
    v_and_b32_dpp v29, v44, v9 row_newbcast:4 row_mask:0xf bank_mask:0xf
    s_waitcnt vmcnt(6)
    s_nop 0
    v_mfma_f32_16x16x32_bf16 v[54:57], v[26:29], v[100:103], v[54:57]
    v_and_b32_dpp v22, v44, v6 row_newbcast:8 row_mask:0xf bank_mask:0xf
    v_and_b32_dpp v23, v44, v7 row_newbcast:8 row_mask:0xf bank_mask:0xf
    v_and_b32_dpp v24, v44, v8 row_newbcast:8 row_mask:0xf bank_mask:0xf
    v_and_b32_dpp v25, v44, v9 row_newbcast:8 row_mask:0xf bank_mask:0xf
    s_waitcnt vmcnt(5)
    s_nop 0
    v_mfma_f32_16x16x32_bf16 v[54:57], v[22:25], v[104:107], v[54:57]
    v_and_b32_dpp v26, v44, v6 row_newbcast:12 row_mask:0xf bank_mask:0xf
    v_and_b32_dpp v27, v44, v7 row_newbcast:12 row_mask:0xf bank_mask:0xf
    v_and_b32_dpp v28, v44, v8 row_newbcast:12 row_mask:0xf bank_mask:0xf
    v_and_b32_dpp v29, v44, v9 row_newbcast:12 row_mask:0xf bank_mask:0xf
    s_waitcnt vmcnt(4)
    s_nop 0
    v_mfma_f32_16x16x32_bf16 v[54:57], v[26:29], v[108:111], v[54:57]
    v_and_b32_dpp v22, v45, v6 row_newbcast:0 row_mask:0xf bank_mask:0xf
    v_and_b32_dpp v23, v45, v7 row_newbcast:0 row_mask:0xf bank_mask:0xf
    v_and_b32_dpp v24, v45, v8 row_newbcast:0 row_mask:0xf bank_mask:0xf
    v_and_b32_dpp v25, v45, v9 row_newbcast:0 row_mask:0xf bank_mask:0xf
    s_waitcnt vmcnt(3)
    s_nop 0
    v_mfma_f32_16x16x32_bf16 v[54:57], v[22:25], v[112:115], v[54:57]
    v_and_b32_dpp v26, v45, v6 row_newbcast:4 row_mask:0xf bank_mask:0xf
    v_and_b32_dpp v27, v45, v7 row_newbcast:4 row_mask:0xf bank_mask:0xf
    v_and_b32_dpp v28, v45, v8 row_newbcast:4 row_mask:0xf bank_mask:0xf
    v_and_b32_dpp v29, v45, v9 row_newbcast:4 row_mask:0xf bank_mask:0xf
    s_waitcnt vmcnt(2)
    s_nop 0
    v_mfma_f32_16x16x32_bf16 v[54:57], v[26:29], v[116:119], v[54:57]
    v_and_b32_dpp v22, v45, v6 row_newbcast:8 row_mask:0xf bank_mask:0xf
    v_and_b32_dpp v23, v45, v7 row_newbcast:8 row_mask:0xf bank_mask:0xf
    v_and_b32_dpp v24, v45, v8 row_newbcast:8 row_mask:0xf bank_mask:0xf
    v_and_b32_dpp v25, v45, v9 row_newbcast:8 row_mask:0xf bank_mask:0xf
    s_waitcnt vmcnt(1)
    s_nop 0
    v_mfma_f32_16x16x32_bf16 v[54:57], v[22:25], v[120:123], v[54:57]
    v_and_b32_dpp v26, v45, v6 row_newbcast:12 row_mask:0xf bank_mask:0xf
    v_and_b32_dpp v27, v45, v7 row_newbcast:12 row_mask:0xf bank_mask:0xf
    v_and_b32_dpp v28, v45, v8 row_newbcast:12 row_mask:0xf bank_mask:0xf
    v_and_b32_dpp v29, v45, v9 row_newbcast:12 row_mask:0xf bank_mask:0xf
    s_waitcnt vmcnt(0)
    s_nop 0
    v_mfma_f32_16x16x32_bf16 v[54:57], v[26:29], v[124:127], v[54:57]
    v_lshlrev_b32 v13, 5, v4
    v_lshl_or_b32 v13, v5, 4, v13
    s_lshl_b32 s53, s50, 9
    v_add_u32 v13, s53, v13
    s_nop 7
    s_mov_b32 exec_hi, 0
    ds_write_b128 v13, v[54:57] offset:2048
    s_mov_b64 exec, -1
    s_waitcnt lgkmcnt(0)
    s_barrier
    s_cmp_lg_u32 s50, 0
    s_cbranch_scc1 B_NONLEADER
    v_lshlrev_b32 v14, 3, v0
    ds_read_b64 v[34:35], v14 offset:2048
    ds_read_b64 v[36:37], v14 offset:2560
    ds_read_b64 v[38:39], v14 offset:3072
    ds_read_b64 v[40:41], v14 offset:3584
    s_waitcnt lgkmcnt(0)
    v_add_f32 v34, v34, v36
    v_add_f32 v34, v34, v38
    v_add_f32 v34, v34, v40
    v_add_f32 v35, v35, v37
    v_add_f32 v35, v35, v39
    v_add_f32 v35, v35, v41
    v_cvt_pk_bf16_f32 v34, v34, v35
    v_mov_b32 v35, s55
    s_lshl_b32 s53, s2, 10
    s_add_u32 s53, s53, 0x180000
    buffer_store_dwordx2 v[34:35], v14, s[12:15], s53 offen sc1
    s_lshl_b32 s53, s51, 12
    s_add_u32 s53, s53, 0x180000
B_QPOLL:
    buffer_load_dwordx2 v[36:37], v14, s[12:15], s53 offen offset:0 sc1
    buffer_load_dwordx2 v[38:39], v14, s[12:15], s53 offen offset:1024 sc1
    buffer_load_dwordx2 v[40:41], v14, s[12:15], s53 offen offset:2048 sc1
    buffer_load_dwordx2 v[42:43], v14, s[12:15], s53 offen offset:3072 sc1
    s_waitcnt vmcnt(0)
    v_min_u32 v15, v37, v39
    v_max_u32 v16, v37, v39
    v_min3_u32 v15, v15, v41, v43
    v_max3_u32 v16, v16, v41, v43
    v_cmp_ne_u32 vcc, s55, v15
    v_cmp_ne_u32 s[78:79], s55, v16
    s_or_b64 vcc, vcc, s[78:79]
    s_cbranch_vccz B_QDONE
    s_add_u32 s76, s76, 1
    s_and_b32 s78, s76, 63
    s_cmp_lg_u32 s78, 63
    s_cbranch_scc1 SPINR6
    s_waitcnt vmcnt(0)
    buffer_inv sc1
    s_waitcnt vmcnt(0)
SPINR6:
    s_cmp_gt_u32 s76, 0x40000
    s_cbranch_scc1 B_QDONE
    s_sleep 4
    s_branch B_QPOLL
B_QDONE:
    v_lshlrev_b32 v13, 2, v0
    ds_write_b32 v13, v36 offset:0
    ds_write_b32 v13, v38 offset:256
    ds_write_b32 v13, v40 offset:512
    ds_write_b32 v13, v42 offset:768
    v_mov_b32 v15, 0
    ds_write_b32 v15, v35 offset:1024
    s_lshl_b32 s57, s50, 12
    s_mov_b32 s60, s57
    s_add_u32 s57, s57, 0x4000
    buffer_load_dwordx4 v[64:67], v1, s[4:7], s60 offen offset:0 nt
    buffer_load_dwordx4 v[68:71], v1, s[4:7], s60 offen offset:1024 nt
    buffer_load_dwordx4 v[72:75], v1, s[4:7], s60 offen offset:2048 nt
    buffer_load_dwordx4 v[76:79], v1, s[4:7], s60 offen offset:3072 nt
    buffer_load_dwordx4 v[80:83], v2, s[8:11], s60 offen offset:0 nt
    buffer_load_dwordx4 v[84:87], v2, s[8:11], s60 offen offset:1024 nt
    buffer_load_dwordx4 v[88:91], v2, s[8:11], s60 offen offset:2048 nt
    buffer_load_dwordx4 v[92:95], v2, s[8:11], s60 offen offset:3072 nt
    s_mov_b32 s61, s57
    s_add_u32 s57, s57, 0x4000
    buffer_load_dwordx4 v[96:99], v1, s[4:7], s61 offen offset:0 nt
    buffer_load_dwordx4 v[100:103], v1, s[4:7], s61 offen offset:1024 nt
    buffer_load_dwordx4 v[104:107], v1, s[4:7], s61 offen offset:2048 nt
    buffer_load_dwordx4 v[108:111], v1, s[4:7], s61 offen offset:3072 nt
    buffer_load_dwordx4 v[112:115], v2, s[8:11], s61 offen offset:0 nt
    buffer_load_dwordx4 v[116:119], v2, s[8:11], s61 offen offset:1024 nt
    buffer_load_dwordx4 v[120:123], v2, s[8:11], s61 offen offset:2048 nt
    buffer_load_dwordx4 v[124:127], v2, s[8:11], s61 offen offset:3072 nt
    s_waitcnt lgkmcnt(0)
    s_branch B_QBAR
B_NONLEADER:
    s_lshl_b32 s57, s50, 12
    s_mov_b32 s60, s57
    s_add_u32 s57, s57, 0x4000
    buffer_load_dwordx4 v[64:67], v1, s[4:7], s60 offen offset:0 nt
    buffer_load_dwordx4 v[68:71], v1, s[4:7], s60 offen offset:1024 nt
    buffer_load_dwordx4 v[72:75], v1, s[4:7], s60 offen offset:2048 nt
    buffer_load_dwordx4 v[76:79], v1, s[4:7], s60 offen offset:3072 nt
    buffer_load_dwordx4 v[80:83], v2, s[8:11], s60 offen offset:0 nt
    buffer_load_dwordx4 v[84:87], v2, s[8:11], s60 offen offset:1024 nt
    buffer_load_dwordx4 v[88:91], v2, s[8:11], s60 offen offset:2048 nt
    buffer_load_dwordx4 v[92:95], v2, s[8:11], s60 offen offset:3072 nt
    s_mov_b32 s61, s57
    s_add_u32 s57, s57, 0x4000
    buffer_load_dwordx4 v[96:99], v1, s[4:7], s61 offen offset:0 nt
    buffer_load_dwordx4 v[100:103], v1, s[4:7], s61 offen offset:1024 nt
    buffer_load_dwordx4 v[104:107], v1, s[4:7], s61 offen offset:2048 nt
    buffer_load_dwordx4 v[108:111], v1, s[4:7], s61 offen offset:3072 nt
    buffer_load_dwordx4 v[112:115], v2, s[8:11], s61 offen offset:0 nt
    buffer_load_dwordx4 v[116:119], v2, s[8:11], s61 offen offset:1024 nt
    buffer_load_dwordx4 v[120:123], v2, s[8:11], s61 offen offset:2048 nt
    buffer_load_dwordx4 v[124:127], v2, s[8:11], s61 offen offset:3072 nt
B_QBAR:
    s_barrier
    ds_read_b128 v[50:53], v1 offset:0
    v_mov_b32 v15, 0
    ds_read_b32 v20, v15 offset:1024
    v_and_b32 v13, 1, v4
    v_cmp_eq_u32 vcc, 1, v13
    v_mov_b32 v14, 0xffff
    v_mov_b32 v15, 0xffff0000
    v_cndmask_b32 v14, v14, v15, vcc
    v_and_b32 v13, 2, v4
    v_cmp_eq_u32 vcc, 0, v13
    s_nop 1
    v_cndmask_b32 v62, 0, v14, vcc
    v_cndmask_b32 v63, v14, 0, vcc
    v_mov_b32 v22, 0
    v_mov_b32 v23, 0
    v_mov_b32 v24, 0
    v_mov_b32 v25, 0
    v_mov_b32 v26, 0
    v_mov_b32 v27, 0
    v_mov_b32 v28, 0
    v_mov_b32 v29, 0
    v_mov_b32 v30, 0
    v_mov_b32 v31, 0
    v_mov_b32 v32, 0
    v_mov_b32 v33, 0
    v_mov_b32 v54, 0
    v_mov_b32 v55, 0
    v_mov_b32 v56, 0
    v_mov_b32 v57, 0
    v_mov_b32 v58, 0
    v_mov_b32 v59, 0
    v_mov_b32 v60, 0
    v_mov_b32 v61, 0
    s_waitcnt lgkmcnt(0)
    v_readfirstlane_b32 s55, v20
    s_nop 1
B_LOOP:
    s_cmp_ge_u32 s60, 0x40000
    s_cbranch_scc1 B_EXIT
    s_waitcnt vmcnt(12)
    v_mfma_f32_16x16x32_bf16 v[34:37], v[64:67], v[50:53], 0
    v_mfma_f32_16x16x32_bf16 v[38:41], v[68:71], v[50:53], 0
    v_mfma_f32_16x16x32_bf16 v[42:45], v[72:75], v[50:53], 0
    v_mfma_f32_16x16x32_bf16 v[46:49], v[76:79], v[50:53], 0
    s_mov_b32 s60, s57
    s_add_u32 s57, s57, 0x4000
    buffer_load_dwordx4 v[64:67], v1, s[4:7], s60 offen offset:0 nt
    buffer_load_dwordx4 v[68:71], v1, s[4:7], s60 offen offset:1024 nt
    buffer_load_dwordx4 v[72:75], v1, s[4:7], s60 offen offset:2048 nt
    buffer_load_dwordx4 v[76:79], v1, s[4:7], s60 offen offset:3072 nt
    s_nop 1
    v_mov_b32_dpp v13, v34 quad_perm:[0,0,0,0] row_mask:0xf bank_mask:0xf
    v_add_f32_dpp v13, v35, v13 quad_perm:[1,1,1,1] row_mask:0xf bank_mask:0xf
    v_add_f32_dpp v13, v36, v13 quad_perm:[2,2,2,2] row_mask:0xf bank_mask:0xf
    v_add_f32_dpp v13, v37, v13 quad_perm:[3,3,3,3] row_mask:0xf bank_mask:0xf
    v_mov_b32_dpp v14, v38 quad_perm:[0,0,0,0] row_mask:0xf bank_mask:0xf
    v_add_f32_dpp v14, v39, v14 quad_perm:[1,1,1,1] row_mask:0xf bank_mask:0xf
    v_add_f32_dpp v14, v40, v14 quad_perm:[2,2,2,2] row_mask:0xf bank_mask:0xf
    v_add_f32_dpp v14, v41, v14 quad_perm:[3,3,3,3] row_mask:0xf bank_mask:0xf
    v_mov_b32_dpp v15, v42 quad_perm:[0,0,0,0] row_mask:0xf bank_mask:0xf
    v_add_f32_dpp v15, v43, v15 quad_perm:[1,1,1,1] row_mask:0xf bank_mask:0xf
    v_add_f32_dpp v15, v44, v15 quad_perm:[2,2,2,2] row_mask:0xf bank_mask:0xf
    v_add_f32_dpp v15, v45, v15 quad_perm:[3,3,3,3] row_mask:0xf bank_mask:0xf
    v_mov_b32_dpp v16, v46 quad_perm:[0,0,0,0] row_mask:0xf bank_mask:0xf
    v_add_f32_dpp v16, v47, v16 quad_perm:[1,1,1,1] row_mask:0xf bank_mask:0xf
    v_add_f32_dpp v16, v48, v16 quad_perm:[2,2,2,2] row_mask:0xf bank_mask:0xf
    v_add_f32_dpp v16, v49, v16 quad_perm:[3,3,3,3] row_mask:0xf bank_mask:0xf
    v_cvt_pk_bf16_f32 v13, v13, v13
    v_and_b32 v13, 0xffff0000, v13
    v_mul_f32 v13, s58, v13
    v_cvt_pk_bf16_f32 v13, v13, v13
    v_and_b32 v13, 0xffff0000, v13
    v_cvt_pk_bf16_f32 v14, v14, v14
    v_and_b32 v14, 0xffff0000, v14
    v_mul_f32 v14, s58, v14
    v_cvt_pk_bf16_f32 v14, v14, v14
    v_and_b32 v14, 0xffff0000, v14
    v_cvt_pk_bf16_f32 v15, v15, v15
    v_and_b32 v15, 0xffff0000, v15
    v_mul_f32 v15, s58, v15
    v_cvt_pk_bf16_f32 v15, v15, v15
    v_and_b32 v15, 0xffff0000, v15
    v_cvt_pk_bf16_f32 v16, v16, v16
    v_and_b32 v16, 0xffff0000, v16
    v_mul_f32 v16, s58, v16
    v_cvt_pk_bf16_f32 v16, v16, v16
    v_and_b32 v16, 0xffff0000, v16
    v_max3_f32 v17, v13, v14, v15
    v_max_f32 v17, v17, v16
    v_cmp_gt_f32 vcc, v17, v10
    s_cbranch_vccnz B_RARE0
B_BACK0:
    v_fma_f32 v13, v13, s59, -v11
    v_exp_f32 v13, v13
    v_fma_f32 v14, v14, s59, -v11
    v_exp_f32 v14, v14
    v_fma_f32 v15, v15, s59, -v11
    v_exp_f32 v15, v15
    v_fma_f32 v16, v16, s59, -v11
    v_exp_f32 v16, v16
    s_nop 0
    v_add_f32 v12, v12, v13
    v_cvt_pk_bf16_f32 v13, v13, v13
    v_add_f32 v12, v12, v14
    v_cvt_pk_bf16_f32 v14, v14, v14
    v_add_f32 v12, v12, v15
    v_cvt_pk_bf16_f32 v15, v15, v15
    v_add_f32 v12, v12, v16
    v_cvt_pk_bf16_f32 v16, v16, v16
    s_waitcnt vmcnt(12)
    v_and_b32 v24, v13, v62
    v_and_b32 v25, v13, v63
    s_nop 1
    v_mfma_f32_16x16x32_bf16 v[54:57], v[24:27], v[80:83], v[54:57]
    v_mfma_f32_16x16x32_bf16 v[58:61], v[22:25], v[80:83], v[58:61]
    v_and_b32 v30, v14, v62
    v_and_b32 v31, v14, v63
    s_nop 1
    v_mfma_f32_16x16x32_bf16 v[54:57], v[30:33], v[84:87], v[54:57]
    v_mfma_f32_16x16x32_bf16 v[58:61], v[28:31], v[84:87], v[58:61]
    v_and_b32 v24, v15, v62
    v_and_b32 v25, v15, v63
    s_nop 1
    v_mfma_f32_16x16x32_bf16 v[54:57], v[24:27], v[88:91], v[54:57]
    v_mfma_f32_16x16x32_bf16 v[58:61], v[22:25], v[88:91], v[58:61]
    v_and_b32 v30, v16, v62
    v_and_b32 v31, v16, v63
    s_nop 1
    v_mfma_f32_16x16x32_bf16 v[54:57], v[30:33], v[92:95], v[54:57]
    v_mfma_f32_16x16x32_bf16 v[58:61], v[28:31], v[92:95], v[58:61]
    buffer_load_dwordx4 v[80:83], v2, s[8:11], s60 offen offset:0 nt
    buffer_load_dwordx4 v[84:87], v2, s[8:11], s60 offen offset:1024 nt
    buffer_load_dwordx4 v[88:91], v2, s[8:11], s60 offen offset:2048 nt
    buffer_load_dwordx4 v[92:95], v2, s[8:11], s60 offen offset:3072 nt
    s_cmp_ge_u32 s61, 0x40000
    s_cbranch_scc1 B_EXIT
    s_waitcnt vmcnt(12)
    v_mfma_f32_16x16x32_bf16 v[34:37], v[96:99], v[50:53], 0
    v_mfma_f32_16x16x32_bf16 v[38:41], v[100:103], v[50:53], 0
    v_mfma_f32_16x16x32_bf16 v[42:45], v[104:107], v[50:53], 0
    v_mfma_f32_16x16x32_bf16 v[46:49], v[108:111], v[50:53], 0
    s_mov_b32 s61, s57
    s_add_u32 s57, s57, 0x4000
    buffer_load_dwordx4 v[96:99], v1, s[4:7], s61 offen offset:0 nt
    buffer_load_dwordx4 v[100:103], v1, s[4:7], s61 offen offset:1024 nt
    buffer_load_dwordx4 v[104:107], v1, s[4:7], s61 offen offset:2048 nt
    buffer_load_dwordx4 v[108:111], v1, s[4:7], s61 offen offset:3072 nt
    s_nop 1
    v_mov_b32_dpp v13, v34 quad_perm:[0,0,0,0] row_mask:0xf bank_mask:0xf
    v_add_f32_dpp v13, v35, v13 quad_perm:[1,1,1,1] row_mask:0xf bank_mask:0xf
    v_add_f32_dpp v13, v36, v13 quad_perm:[2,2,2,2] row_mask:0xf bank_mask:0xf
    v_add_f32_dpp v13, v37, v13 quad_perm:[3,3,3,3] row_mask:0xf bank_mask:0xf
    v_mov_b32_dpp v14, v38 quad_perm:[0,0,0,0] row_mask:0xf bank_mask:0xf
    v_add_f32_dpp v14, v39, v14 quad_perm:[1,1,1,1] row_mask:0xf bank_mask:0xf
    v_add_f32_dpp v14, v40, v14 quad_perm:[2,2,2,2] row_mask:0xf bank_mask:0xf
    v_add_f32_dpp v14, v41, v14 quad_perm:[3,3,3,3] row_mask:0xf bank_mask:0xf
    v_mov_b32_dpp v15, v42 quad_perm:[0,0,0,0] row_mask:0xf bank_mask:0xf
    v_add_f32_dpp v15, v43, v15 quad_perm:[1,1,1,1] row_mask:0xf bank_mask:0xf
    v_add_f32_dpp v15, v44, v15 quad_perm:[2,2,2,2] row_mask:0xf bank_mask:0xf
    v_add_f32_dpp v15, v45, v15 quad_perm:[3,3,3,3] row_mask:0xf bank_mask:0xf
    v_mov_b32_dpp v16, v46 quad_perm:[0,0,0,0] row_mask:0xf bank_mask:0xf
    v_add_f32_dpp v16, v47, v16 quad_perm:[1,1,1,1] row_mask:0xf bank_mask:0xf
    v_add_f32_dpp v16, v48, v16 quad_perm:[2,2,2,2] row_mask:0xf bank_mask:0xf
    v_add_f32_dpp v16, v49, v16 quad_perm:[3,3,3,3] row_mask:0xf bank_mask:0xf
    v_cvt_pk_bf16_f32 v13, v13, v13
    v_and_b32 v13, 0xffff0000, v13
    v_mul_f32 v13, s58, v13
    v_cvt_pk_bf16_f32 v13, v13, v13
    v_and_b32 v13, 0xffff0000, v13
    v_cvt_pk_bf16_f32 v14, v14, v14
    v_and_b32 v14, 0xffff0000, v14
    v_mul_f32 v14, s58, v14
    v_cvt_pk_bf16_f32 v14, v14, v14
    v_and_b32 v14, 0xffff0000, v14
    v_cvt_pk_bf16_f32 v15, v15, v15
    v_and_b32 v15, 0xffff0000, v15
    v_mul_f32 v15, s58, v15
    v_cvt_pk_bf16_f32 v15, v15, v15
    v_and_b32 v15, 0xffff0000, v15
    v_cvt_pk_bf16_f32 v16, v16, v16
    v_and_b32 v16, 0xffff0000, v16
    v_mul_f32 v16, s58, v16
    v_cvt_pk_bf16_f32 v16, v16, v16
    v_and_b32 v16, 0xffff0000, v16
    v_max3_f32 v17, v13, v14, v15
    v_max_f32 v17, v17, v16
    v_cmp_gt_f32 vcc, v17, v10
    s_cbranch_vccnz B_RARE1
B_BACK1:
    v_fma_f32 v13, v13, s59, -v11
    v_exp_f32 v13, v13
    v_fma_f32 v14, v14, s59, -v11
    v_exp_f32 v14, v14
    v_fma_f32 v15, v15, s59, -v11
    v_exp_f32 v15, v15
    v_fma_f32 v16, v16, s59, -v11
    v_exp_f32 v16, v16
    s_nop 0
    v_add_f32 v12, v12, v13
    v_cvt_pk_bf16_f32 v13, v13, v13
    v_add_f32 v12, v12, v14
    v_cvt_pk_bf16_f32 v14, v14, v14
    v_add_f32 v12, v12, v15
    v_cvt_pk_bf16_f32 v15, v15, v15
    v_add_f32 v12, v12, v16
    v_cvt_pk_bf16_f32 v16, v16, v16
    s_waitcnt vmcnt(12)
    v_and_b32 v24, v13, v62
    v_and_b32 v25, v13, v63
    s_nop 1
    v_mfma_f32_16x16x32_bf16 v[54:57], v[24:27], v[112:115], v[54:57]
    v_mfma_f32_16x16x32_bf16 v[58:61], v[22:25], v[112:115], v[58:61]
    v_and_b32 v30, v14, v62
    v_and_b32 v31, v14, v63
    s_nop 1
    v_mfma_f32_16x16x32_bf16 v[54:57], v[30:33], v[116:119], v[54:57]
    v_mfma_f32_16x16x32_bf16 v[58:61], v[28:31], v[116:119], v[58:61]
    v_and_b32 v24, v15, v62
    v_and_b32 v25, v15, v63
    s_nop 1
    v_mfma_f32_16x16x32_bf16 v[54:57], v[24:27], v[120:123], v[54:57]
    v_mfma_f32_16x16x32_bf16 v[58:61], v[22:25], v[120:123], v[58:61]
    v_and_b32 v30, v16, v62
    v_and_b32 v31, v16, v63
    s_nop 1
    v_mfma_f32_16x16x32_bf16 v[54:57], v[30:33], v[124:127], v[54:57]
    v_mfma_f32_16x16x32_bf16 v[58:61], v[28:31], v[124:127], v[58:61]
    buffer_load_dwordx4 v[112:115], v2, s[8:11], s61 offen offset:0 nt
    buffer_load_dwordx4 v[116:119], v2, s[8:11], s61 offen offset:1024 nt
    buffer_load_dwordx4 v[120:123], v2, s[8:11], s61 offen offset:2048 nt
    buffer_load_dwordx4 v[124:127], v2, s[8:11], s61 offen offset:3072 nt
    s_branch B_LOOP
B_RARE0:
    v_mov_b32 v18, v17
    v_mov_b32 v19, v17
    s_nop 1
    v_permlane16_swap_b32 v18, v19
    s_nop 0
    v_max_f32 v17, v18, v19
    v_mov_b32 v18, v17
    v_mov_b32 v19, v17
    s_nop 1
    v_permlane32_swap_b32 v18, v19
    s_nop 0
    v_max_f32 v17, v18, v19
    v_max_f32 v17, v17, v10
    v_mul_f32 v18, s59, v17
    v_sub_f32 v19, v11, v18
    v_exp_f32 v19, v19
    v_mov_b32 v10, v17
    v_mov_b32 v11, v18
    v_lshlrev_b32 v18, 4, v5
    ds_bpermute_b32 v17, v18, v19
    v_mul_f32 v12, v12, v19
    s_waitcnt lgkmcnt(0)
    s_nop 7
    v_mul_f32 v54, v54, v17
    v_mul_f32 v55, v55, v17
    v_mul_f32 v56, v56, v17
    v_mul_f32 v57, v57, v17
    v_mul_f32 v58, v58, v17
    v_mul_f32 v59, v59, v17
    v_mul_f32 v60, v60, v17
    v_mul_f32 v61, v61, v17
    s_branch B_BACK0
B_RARE1:
    v_mov_b32 v18, v17
    v_mov_b32 v19, v17
    s_nop 1
    v_permlane16_swap_b32 v18, v19
    s_nop 0
    v_max_f32 v17, v18, v19
    v_mov_b32 v18, v17
    v_mov_b32 v19, v17
    s_nop 1
    v_permlane32_swap_b32 v18, v19
    s_nop 0
    v_max_f32 v17, v18, v19
    v_max_f32 v17, v17, v10
    v_mul_f32 v18, s59, v17
    v_sub_f32 v19, v11, v18
    v_exp_f32 v19, v19
    v_mov_b32 v10, v17
    v_mov_b32 v11, v18
    v_lshlrev_b32 v18, 4, v5
    ds_bpermute_b32 v17, v18, v19
    v_mul_f32 v12, v12, v19
    s_waitcnt lgkmcnt(0)
    s_nop 7
    v_mul_f32 v54, v54, v17
    v_mul_f32 v55, v55, v17
    v_mul_f32 v56, v56, v17
    v_mul_f32 v57, v57, v17
    v_mul_f32 v58, v58, v17
    v_mul_f32 v59, v59, v17
    v_mul_f32 v60, v60, v17
    v_mul_f32 v61, v61, v17
    s_branch B_BACK1
B_EXIT:
    s_waitcnt vmcnt(0)
    v_mov_b32 v13, v12
    v_mov_b32 v14, v12
    s_nop 1
    v_permlane16_swap_b32 v13, v14
    s_nop 0
    v_add_f32 v12, v13, v14
    v_mov_b32 v13, v12
    v_mov_b32 v14, v12
    s_nop 1
    v_permlane32_swap_b32 v13, v14
    s_nop 0
    v_add_f32 v12, v13, v14
    v_lshlrev_b32 v13, 5, v4
    v_lshl_or_b32 v13, v5, 9, v13
    s_lshl_b32 s53, s50, 11
    v_add_u32 v13, s53, v13
    ds_write_b128 v13, v[54:57] offset:2048
    ds_write_b128 v13, v[58:61] offset:2064
    v_lshrrev_b32 v14, 2, v4
    v_lshlrev_b32 v14, 5, v14
    s_lshl_b32 s53, s50, 3
    v_add_u32 v14, s53, v14
    v_mov_b32 v16, v11
    v_mov_b32 v17, v12
    ds_write_b64 v14, v[16:17] offset:10240
    s_waitcnt lgkmcnt(0)
    s_barrier
    s_lshl_b32 s53, s50, 5
    v_mov_b32 v13, s53
    ds_read_b128 v[34:37], v13 offset:10240
    ds_read_b128 v[38:41], v13 offset:10256
    v_lshlrev_b32 v14, 3, v0
    s_lshl_b32 s53, s50, 9
    v_add_u32 v14, s53, v14
    ds_read_b64 v[42:43], v14 offset:2048
    ds_read_b64 v[44:45], v14 offset:4096
    ds_read_b64 v[46:47], v14 offset:6144
    ds_read_b64 v[48:49], v14 offset:8192
    s_waitcnt lgkmcnt(0)
    v_max3_f32 v11, v34, v36, v38
    v_max_f32 v11, v11, v40
    v_sub_f32 v34, v34, v11
    v_exp_f32 v34, v34
    v_sub_f32 v36, v36, v11
    v_exp_f32 v36, v36
    v_sub_f32 v38, v38, v11
    v_exp_f32 v38, v38
    v_sub_f32 v40, v40, v11
    v_exp_f32 v40, v40
    s_nop 0
    v_mul_f32 v12, v34, v35
    v_mul_f32 v50, v34, v42
    v_mul_f32 v52, v34, v43
    v_fmac_f32 v12, v36, v37
    v_fmac_f32 v50, v36, v44
    v_fmac_f32 v52, v36, v45
    v_fmac_f32 v12, v38, v39
    v_fmac_f32 v50, v38, v46
    v_fmac_f32 v52, v38, v47
    v_fmac_f32 v12, v40, v41
    v_fmac_f32 v50, v40, v48
    v_fmac_f32 v52, v40, v49
    v_mov_b32 v51, s55
    v_mov_b32 v53, s55
    v_mov_b32 v54, v11
    v_mov_b32 v55, s55
    v_mov_b32 v56, v12
    v_mov_b32 v57, s55
    s_lshl_b32 s53, s51, 2
    s_add_u32 s53, s53, s50
    s_lshl_b32 s53, s53, 2
    s_add_u32 s53, s53, s52
    s_lshl_b32 s53, s53, 11
    s_add_u32 s53, s53, 0x1a0000
    v_mov_b32 v16, 0x40000000
    v_cmp_eq_u32 vcc, 0, v0
    buffer_store_dwordx4 v[50:53], v2, s[12:15], s53 offen sc1
    s_nop 0
    v_cndmask_b32 v15, v16, 0, vcc
    buffer_store_dwordx4 v[54:57], v15, s[12:15], s53 offen offset:1024 sc1
    s_cmp_lg_u32 s50, 0
    s_cbranch_scc1 B_OBAR
    s_lshl_b32 s53, s2, 13
    s_add_u32 s53, s53, 0x1a0000
    v_and_b32 v13, 3, v0
    v_lshlrev_b32 v13, 11, v13
    v_add_u32 v14, 4096, v2
    s_nop 1
B_PPOLL:
    buffer_load_dwordx4 v[22:25], v2, s[12:15], s53 offen offset:0 sc1
    buffer_load_dwordx4 v[26:29], v2, s[12:15], s53 offen offset:2048 sc1
    buffer_load_dwordx4 v[30:33], v14, s[12:15], s53 offen offset:0 sc1
    buffer_load_dwordx4 v[34:37], v14, s[12:15], s53 offen offset:2048 sc1
    buffer_load_dwordx4 v[38:41], v13, s[12:15], s53 offen offset:1024 sc1
    s_waitcnt vmcnt(0)
    v_min_u32 v15, v23, v25
    v_max_u32 v16, v23, v25
    v_min3_u32 v15, v15, v27, v29
    v_max3_u32 v16, v16, v27, v29
    v_min3_u32 v15, v15, v31, v33
    v_max3_u32 v16, v16, v31, v33
    v_min3_u32 v15, v15, v35, v37
    v_max3_u32 v16, v16, v35, v37
    v_min3_u32 v15, v15, v39, v41
    v_max3_u32 v16, v16, v39, v41
    v_cmp_ne_u32 vcc, s55, v15
    v_cmp_ne_u32 s[78:79], s55, v16
    s_or_b64 vcc, vcc, s[78:79]
    s_cbranch_vccz B_PDONE
    s_add_u32 s76, s76, 1
    s_and_b32 s78, s76, 63
    s_cmp_lg_u32 s78, 63
    s_cbranch_scc1 SPINR7
    s_waitcnt vmcnt(0)
    buffer_inv sc1
    s_waitcnt vmcnt(0)
SPINR7:
    s_cmp_gt_u32 s76, 0x40000
    s_cbranch_scc1 B_PDONE
    s_sleep 4
    s_branch B_PPOLL
B_PDONE:
    v_mov_b32 v15, v38
    s_nop 1
    v_max_f32_dpp v15, v15, v15 row_ror:1 row_mask:0xf bank_mask:0xf
    s_nop 1
    v_max_f32_dpp v15, v15, v15 row_ror:2 row_mask:0xf bank_mask:0xf
    v_sub_f32 v16, v38, v15
    v_exp_f32 v16, v16
    s_nop 0
    v_mul_f32 v17, v16, v40
    s_nop 1
    v_add_f32_dpp v17, v17, v17 row_ror:1 row_mask:0xf bank_mask:0xf
    s_nop 1
    v_add_f32_dpp v17, v17, v17 row_ror:2 row_mask:0xf bank_mask:0xf
    v_rcp_f32 v17, v17
    v_mov_b32 v18, 0
    v_mov_b32 v19, 0
    v_fmac_f32_dpp v18, v16, v22 row_newbcast:0 row_mask:0xf bank_mask:0xf
    v_fmac_f32_dpp v19, v16, v24 row_newbcast:0 row_mask:0xf bank_mask:0xf
    v_fmac_f32_dpp v18, v16, v26 row_newbcast:1 row_mask:0xf bank_mask:0xf
    v_fmac_f32_dpp v19, v16, v28 row_newbcast:1 row_mask:0xf bank_mask:0xf
    v_fmac_f32_dpp v18, v16, v30 row_newbcast:2 row_mask:0xf bank_mask:0xf
    v_fmac_f32_dpp v19, v16, v32 row_newbcast:2 row_mask:0xf bank_mask:0xf
    v_fmac_f32_dpp v18, v16, v34 row_newbcast:3 row_mask:0xf bank_mask:0xf
    v_fmac_f32_dpp v19, v16, v36 row_newbcast:3 row_mask:0xf bank_mask:0xf
    v_mul_f32 v18, v18, v17
    v_mul_f32 v19, v19, v17
    v_cvt_pk_bf16_f32 v18, v18, v19
    v_lshlrev_b32 v13, 2, v0
    ds_write_b32 v13, v18 offset:10496
    s_waitcnt lgkmcnt(0)
B_OBAR:
    s_barrier
    v_lshrrev_b32 v13, 2, v4
    v_lshlrev_b32 v13, 4, v13
    v_lshl_or_b32 v13, v5, 6, v13
    ds_read_b128 v[34:37], v13 offset:10496
    s_mov_b32 s16, s42
    s_mov_b32 s17, s43
    s_mov_b32 s18, 0x400000
    s_mov_b32 s19, 0x00020000
    v_lshlrev_b32 v14, 15, v5
    v_lshl_or_b32 v14, v4, 4, v14
    s_lshl_b32 s53, s2, 17
    s_lshl_b32 s54, s50, 8
    s_add_u32 s53, s53, s54
    s_waitcnt vmcnt(0)
    s_add_u32 s54, s53, 0x0
    buffer_load_dwordx4 v[64:67], v14, s[16:19], s54 offen nt
    s_add_u32 s54, s53, 0x2000
    buffer_load_dwordx4 v[68:71], v14, s[16:19], s54 offen nt
    s_add_u32 s54, s53, 0x4000
    buffer_load_dwordx4 v[72:75], v14, s[16:19], s54 offen nt
    s_add_u32 s54, s53, 0x6000
    buffer_load_dwordx4 v[76:79], v14, s[16:19], s54 offen nt
    s_add_u32 s54, s53, 0x400
    buffer_load_dwordx4 v[80:83], v14, s[16:19], s54 offen nt
    s_add_u32 s54, s53, 0x2400
    buffer_load_dwordx4 v[84:87], v14, s[16:19], s54 offen nt
    s_add_u32 s54, s53, 0x4400
    buffer_load_dwordx4 v[88:91], v14, s[16:19], s54 offen nt
    s_add_u32 s54, s53, 0x6400
    buffer_load_dwordx4 v[92:95], v14, s[16:19], s54 offen nt
    s_add_u32 s54, s53, 0x800
    buffer_load_dwordx4 v[96:99], v14, s[16:19], s54 offen nt
    s_add_u32 s54, s53, 0x2800
    buffer_load_dwordx4 v[100:103], v14, s[16:19], s54 offen nt
    s_add_u32 s54, s53, 0x4800
    buffer_load_dwordx4 v[104:107], v14, s[16:19], s54 offen nt
    s_add_u32 s54, s53, 0x6800
    buffer_load_dwordx4 v[108:111], v14, s[16:19], s54 offen nt
    s_add_u32 s54, s53, 0xc00
    buffer_load_dwordx4 v[112:115], v14, s[16:19], s54 offen nt
    s_add_u32 s54, s53, 0x2c00
    buffer_load_dwordx4 v[116:119], v14, s[16:19], s54 offen nt
    s_add_u32 s54, s53, 0x4c00
    buffer_load_dwordx4 v[120:123], v14, s[16:19], s54 offen nt
    s_add_u32 s54, s53, 0x6c00
    buffer_load_dwordx4 v[124:127], v14, s[16:19], s54 offen nt
    s_waitcnt lgkmcnt(0)
    v_perm_b32 v38, v34, v34, s74
    v_perm_b32 v39, v34, v34, s75
    v_perm_b32 v40, v35, v35, s74
    v_perm_b32 v41, v35, v35, s75
    v_perm_b32 v42, v36, v36, s74
    v_perm_b32 v43, v36, v36, s75
    v_perm_b32 v44, v37, v37, s74
    v_perm_b32 v45, v37, v37, s75
    s_nop 1
    v_and_b32_dpp v22, v38, v6 row_newbcast:0 row_mask:0xf bank_mask:0xf
    v_and_b32_dpp v23, v38, v7 row_newbcast:0 row_mask:0xf bank_mask:0xf
    v_and_b32_dpp v24, v38, v8 row_newbcast:0 row_mask:0xf bank_mask:0xf
    v_and_b32_dpp v25, v38, v9 row_newbcast:0 row_mask:0xf bank_mask:0xf
    s_waitcnt vmcnt(15)
    s_nop 0
    v_mfma_f32_16x16x32_bf16 v[54:57], v[22:25], v[64:67], 0
    v_and_b32_dpp v26, v38, v6 row_newbcast:4 row_mask:0xf bank_mask:0xf
    v_and_b32_dpp v27, v38, v7 row_newbcast:4 row_mask:0xf bank_mask:0xf
    v_and_b32_dpp v28, v38, v8 row_newbcast:4 row_mask:0xf bank_mask:0xf
    v_and_b32_dpp v29, v38, v9 row_newbcast:4 row_mask:0xf bank_mask:0xf
    s_waitcnt vmcnt(14)
    s_nop 0
    v_mfma_f32_16x16x32_bf16 v[54:57], v[26:29], v[68:71], v[54:57]
    v_and_b32_dpp v22, v38, v6 row_newbcast:8 row_mask:0xf bank_mask:0xf
    v_and_b32_dpp v23, v38, v7 row_newbcast:8 row_mask:0xf bank_mask:0xf
    v_and_b32_dpp v24, v38, v8 row_newbcast:8 row_mask:0xf bank_mask:0xf
    v_and_b32_dpp v25, v38, v9 row_newbcast:8 row_mask:0xf bank_mask:0xf
    s_waitcnt vmcnt(13)
    s_nop 0
    v_mfma_f32_16x16x32_bf16 v[54:57], v[22:25], v[72:75], v[54:57]
    v_and_b32_dpp v26, v38, v6 row_newbcast:12 row_mask:0xf bank_mask:0xf
    v_and_b32_dpp v27, v38, v7 row_newbcast:12 row_mask:0xf bank_mask:0xf
    v_and_b32_dpp v28, v38, v8 row_newbcast:12 row_mask:0xf bank_mask:0xf
    v_and_b32_dpp v29, v38, v9 row_newbcast:12 row_mask:0xf bank_mask:0xf
    s_waitcnt vmcnt(12)
    s_nop 0
    v_mfma_f32_16x16x32_bf16 v[54:57], v[26:29], v[76:79], v[54:57]
    v_and_b32_dpp v22, v39, v6 row_newbcast:0 row_mask:0xf bank_mask:0xf
    v_and_b32_dpp v23, v39, v7 row_newbcast:0 row_mask:0xf bank_mask:0xf
    v_and_b32_dpp v24, v39, v8 row_newbcast:0 row_mask:0xf bank_mask:0xf
    v_and_b32_dpp v25, v39, v9 row_newbcast:0 row_mask:0xf bank_mask:0xf
    s_waitcnt vmcnt(11)
    s_nop 0
    v_mfma_f32_16x16x32_bf16 v[54:57], v[22:25], v[80:83], v[54:57]
    v_and_b32_dpp v26, v39, v6 row_newbcast:4 row_mask:0xf bank_mask:0xf
    v_and_b32_dpp v27, v39, v7 row_newbcast:4 row_mask:0xf bank_mask:0xf
    v_and_b32_dpp v28, v39, v8 row_newbcast:4 row_mask:0xf bank_mask:0xf
    v_and_b32_dpp v29, v39, v9 row_newbcast:4 row_mask:0xf bank_mask:0xf
    s_waitcnt vmcnt(10)
    s_nop 0
    v_mfma_f32_16x16x32_bf16 v[54:57], v[26:29], v[84:87], v[54:57]
    v_and_b32_dpp v22, v39, v6 row_newbcast:8 row_mask:0xf bank_mask:0xf
    v_and_b32_dpp v23, v39, v7 row_newbcast:8 row_mask:0xf bank_mask:0xf
    v_and_b32_dpp v24, v39, v8 row_newbcast:8 row_mask:0xf bank_mask:0xf
    v_and_b32_dpp v25, v39, v9 row_newbcast:8 row_mask:0xf bank_mask:0xf
    s_waitcnt vmcnt(9)
    s_nop 0
    v_mfma_f32_16x16x32_bf16 v[54:57], v[22:25], v[88:91], v[54:57]
    v_and_b32_dpp v26, v39, v6 row_newbcast:12 row_mask:0xf bank_mask:0xf
    v_and_b32_dpp v27, v39, v7 row_newbcast:12 row_mask:0xf bank_mask:0xf
    v_and_b32_dpp v28, v39, v8 row_newbcast:12 row_mask:0xf bank_mask:0xf
    v_and_b32_dpp v29, v39, v9 row_newbcast:12 row_mask:0xf bank_mask:0xf
    s_waitcnt vmcnt(8)
    s_nop 0
    v_mfma_f32_16x16x32_bf16 v[54:57], v[26:29], v[92:95], v[54:57]
    v_and_b32_dpp v22, v40, v6 row_newbcast:0 row_mask:0xf bank_mask:0xf
    v_and_b32_dpp v23, v40, v7 row_newbcast:0 row_mask:0xf bank_mask:0xf
    v_and_b32_dpp v24, v40, v8 row_newbcast:0 row_mask:0xf bank_mask:0xf
    v_and_b32_dpp v25, v40, v9 row_newbcast:0 row_mask:0xf bank_mask:0xf
    s_waitcnt vmcnt(7)
    s_nop 0
    v_mfma_f32_16x16x32_bf16 v[54:57], v[22:25], v[96:99], v[54:57]
    v_and_b32_dpp v26, v40, v6 row_newbcast:4 row_mask:0xf bank_mask:0xf
    v_and_b32_dpp v27, v40, v7 row_newbcast:4 row_mask:0xf bank_mask:0xf
    v_and_b32_dpp v28, v40, v8 row_newbcast:4 row_mask:0xf bank_mask:0xf
    v_and_b32_dpp v29, v40, v9 row_newbcast:4 row_mask:0xf bank_mask:0xf
    s_waitcnt vmcnt(6)
    s_nop 0
    v_mfma_f32_16x16x32_bf16 v[54:57], v[26:29], v[100:103], v[54:57]
    v_and_b32_dpp v22, v40, v6 row_newbcast:8 row_mask:0xf bank_mask:0xf
    v_and_b32_dpp v23, v40, v7 row_newbcast:8 row_mask:0xf bank_mask:0xf
    v_and_b32_dpp v24, v40, v8 row_newbcast:8 row_mask:0xf bank_mask:0xf
    v_and_b32_dpp v25, v40, v9 row_newbcast:8 row_mask:0xf bank_mask:0xf
    s_waitcnt vmcnt(5)
    s_nop 0
    v_mfma_f32_16x16x32_bf16 v[54:57], v[22:25], v[104:107], v[54:57]
    v_and_b32_dpp v26, v40, v6 row_newbcast:12 row_mask:0xf bank_mask:0xf
    v_and_b32_dpp v27, v40, v7 row_newbcast:12 row_mask:0xf bank_mask:0xf
    v_and_b32_dpp v28, v40, v8 row_newbcast:12 row_mask:0xf bank_mask:0xf
    v_and_b32_dpp v29, v40, v9 row_newbcast:12 row_mask:0xf bank_mask:0xf
    s_waitcnt vmcnt(4)
    s_nop 0
    v_mfma_f32_16x16x32_bf16 v[54:57], v[26:29], v[108:111], v[54:57]
    v_and_b32_dpp v22, v41, v6 row_newbcast:0 row_mask:0xf bank_mask:0xf
    v_and_b32_dpp v23, v41, v7 row_newbcast:0 row_mask:0xf bank_mask:0xf
    v_and_b32_dpp v24, v41, v8 row_newbcast:0 row_mask:0xf bank_mask:0xf
    v_and_b32_dpp v25, v41, v9 row_newbcast:0 row_mask:0xf bank_mask:0xf
    s_waitcnt vmcnt(3)
    s_nop 0
    v_mfma_f32_16x16x32_bf16 v[54:57], v[22:25], v[112:115], v[54:57]
    v_and_b32_dpp v26, v41, v6 row_newbcast:4 row_mask:0xf bank_mask:0xf
    v_and_b32_dpp v27, v41, v7 row_newbcast:4 row_mask:0xf bank_mask:0xf
    v_and_b32_dpp v28, v41, v8 row_newbcast:4 row_mask:0xf bank_mask:0xf
    v_and_b32_dpp v29, v41, v9 row_newbcast:4 row_mask:0xf bank_mask:0xf
    s_waitcnt vmcnt(2)
    s_nop 0
    v_mfma_f32_16x16x32_bf16 v[54:57], v[26:29], v[116:119], v[54:57]
    v_and_b32_dpp v22, v41, v6 row_newbcast:8 row_mask:0xf bank_mask:0xf
    v_and_b32_dpp v23, v41, v7 row_newbcast:8 row_mask:0xf bank_mask:0xf
    v_and_b32_dpp v24, v41, v8 row_newbcast:8 row_mask:0xf bank_mask:0xf
    v_and_b32_dpp v25, v41, v9 row_newbcast:8 row_mask:0xf bank_mask:0xf
    s_waitcnt vmcnt(1)
    s_nop 0
    v_mfma_f32_16x16x32_bf16 v[54:57], v[22:25], v[120:123], v[54:57]
    v_and_b32_dpp v26, v41, v6 row_newbcast:12 row_mask:0xf bank_mask:0xf
    v_and_b32_dpp v27, v41, v7 row_newbcast:12 row_mask:0xf bank_mask:0xf
    v_and_b32_dpp v28, v41, v8 row_newbcast:12 row_mask:0xf bank_mask:0xf
    v_and_b32_dpp v29, v41, v9 row_newbcast:12 row_mask:0xf bank_mask:0xf
    s_waitcnt vmcnt(0)
    s_nop 0
    v_mfma_f32_16x16x32_bf16 v[54:57], v[26:29], v[124:127], v[54:57]
    s_add_u32 s54, s53, 0x1000
    buffer_load_dwordx4 v[64:67], v14, s[16:19], s54 offen nt
    s_add_u32 s54, s53, 0x3000
    buffer_load_dwordx4 v[68:71], v14, s[16:19], s54 offen nt
    s_add_u32 s54, s53, 0x5000
    buffer_load_dwordx4 v[72:75], v14, s[16:19], s54 offen nt
    s_add_u32 s54, s53, 0x7000
    buffer_load_dwordx4 v[76:79], v14, s[16:19], s54 offen nt
    s_add_u32 s54, s53, 0x1400
    buffer_load_dwordx4 v[80:83], v14, s[16:19], s54 offen nt
    s_add_u32 s54, s53, 0x3400
    buffer_load_dwordx4 v[84:87], v14, s[16:19], s54 offen nt
    s_add_u32 s54, s53, 0x5400
    buffer_load_dwordx4 v[88:91], v14, s[16:19], s54 offen nt
    s_add_u32 s54, s53, 0x7400
    buffer_load_dwordx4 v[92:95], v14, s[16:19], s54 offen nt
    s_add_u32 s54, s53, 0x1800
    buffer_load_dwordx4 v[96:99], v14, s[16:19], s54 offen nt
    s_add_u32 s54, s53, 0x3800
    buffer_load_dwordx4 v[100:103], v14, s[16:19], s54 offen nt
    s_add_u32 s54, s53, 0x5800
    buffer_load_dwordx4 v[104:107], v14, s[16:19], s54 offen nt
    s_add_u32 s54, s53, 0x7800
    buffer_load_dwordx4 v[108:111], v14, s[16:19], s54 offen nt
    s_add_u32 s54, s53, 0x1c00
    buffer_load_dwordx4 v[112:115], v14, s[16:19], s54 offen nt
    s_add_u32 s54, s53, 0x3c00
    buffer_load_dwordx4 v[116:119], v14, s[16:19], s54 offen nt
    s_add_u32 s54, s53, 0x5c00
    buffer_load_dwordx4 v[120:123], v14, s[16:19], s54 offen nt
    s_add_u32 s54, s53, 0x7c00
    buffer_load_dwordx4 v[124:127], v14, s[16:19], s54 offen nt
    v_and_b32_dpp v22, v42, v6 row_newbcast:0 row_mask:0xf bank_mask:0xf
    v_and_b32_dpp v23, v42, v7 row_newbcast:0 row_mask:0xf bank_mask:0xf
    v_and_b32_dpp v24, v42, v8 row_newbcast:0 row_mask:0xf bank_mask:0xf
    v_and_b32_dpp v25, v42, v9 row_newbcast:0 row_mask:0xf bank_mask:0xf
    s_waitcnt vmcnt(15)
    s_nop 0
    v_mfma_f32_16x16x32_bf16 v[54:57], v[22:25], v[64:67], v[54:57]
    v_and_b32_dpp v26, v42, v6 row_newbcast:4 row_mask:0xf bank_mask:0xf
    v_and_b32_dpp v27, v42, v7 row_newbcast:4 row_mask:0xf bank_mask:0xf
    v_and_b32_dpp v28, v42, v8 row_newbcast:4 row_mask:0xf bank_mask:0xf
    v_and_b32_dpp v29, v42, v9 row_newbcast:4 row_mask:0xf bank_mask:0xf
    s_waitcnt vmcnt(14)
    s_nop 0
    v_mfma_f32_16x16x32_bf16 v[54:57], v[26:29], v[68:71], v[54:57]
    v_and_b32_dpp v22, v42, v6 row_newbcast:8 row_mask:0xf bank_mask:0xf
    v_and_b32_dpp v23, v42, v7 row_newbcast:8 row_mask:0xf bank_mask:0xf
    v_and_b32_dpp v24, v42, v8 row_newbcast:8 row_mask:0xf bank_mask:0xf
    v_and_b32_dpp v25, v42, v9 row_newbcast:8 row_mask:0xf bank_mask:0xf
    s_waitcnt vmcnt(13)
    s_nop 0
    v_mfma_f32_16x16x32_bf16 v[54:57], v[22:25], v[72:75], v[54:57]
    v_and_b32_dpp v26, v42, v6 row_newbcast:12 row_mask:0xf bank_mask:0xf
    v_and_b32_dpp v27, v42, v7 row_newbcast:12 row_mask:0xf bank_mask:0xf
    v_and_b32_dpp v28, v42, v8 row_newbcast:12 row_mask:0xf bank_mask:0xf
    v_and_b32_dpp v29, v42, v9 row_newbcast:12 row_mask:0xf bank_mask:0xf
    s_waitcnt vmcnt(12)
    s_nop 0
    v_mfma_f32_16x16x32_bf16 v[54:57], v[26:29], v[76:79], v[54:57]
    v_and_b32_dpp v22, v43, v6 row_newbcast:0 row_mask:0xf bank_mask:0xf
    v_and_b32_dpp v23, v43, v7 row_newbcast:0 row_mask:0xf bank_mask:0xf
    v_and_b32_dpp v24, v43, v8 row_newbcast:0 row_mask:0xf bank_mask:0xf
    v_and_b32_dpp v25, v43, v9 row_newbcast:0 row_mask:0xf bank_mask:0xf
    s_waitcnt vmcnt(11)
    s_nop 0
    v_mfma_f32_16x16x32_bf16 v[54:57], v[22:25], v[80:83], v[54:57]
    v_and_b32_dpp v26, v43, v6 row_newbcast:4 row_mask:0xf bank_mask:0xf
    v_and_b32_dpp v27, v43, v7 row_newbcast:4 row_mask:0xf bank_mask:0xf
    v_and_b32_dpp v28, v43, v8 row_newbcast:4 row_mask:0xf bank_mask:0xf
    v_and_b32_dpp v29, v43, v9 row_newbcast:4 row_mask:0xf bank_mask:0xf
    s_waitcnt vmcnt(10)
    s_nop 0
    v_mfma_f32_16x16x32_bf16 v[54:57], v[26:29], v[84:87], v[54:57]
    v_and_b32_dpp v22, v43, v6 row_newbcast:8 row_mask:0xf bank_mask:0xf
    v_and_b32_dpp v23, v43, v7 row_newbcast:8 row_mask:0xf bank_mask:0xf
    v_and_b32_dpp v24, v43, v8 row_newbcast:8 row_mask:0xf bank_mask:0xf
    v_and_b32_dpp v25, v43, v9 row_newbcast:8 row_mask:0xf bank_mask:0xf
    s_waitcnt vmcnt(9)
    s_nop 0
    v_mfma_f32_16x16x32_bf16 v[54:57], v[22:25], v[88:91], v[54:57]
    v_and_b32_dpp v26, v43, v6 row_newbcast:12 row_mask:0xf bank_mask:0xf
    v_and_b32_dpp v27, v43, v7 row_newbcast:12 row_mask:0xf bank_mask:0xf
    v_and_b32_dpp v28, v43, v8 row_newbcast:12 row_mask:0xf bank_mask:0xf
    v_and_b32_dpp v29, v43, v9 row_newbcast:12 row_mask:0xf bank_mask:0xf
    s_waitcnt vmcnt(8)
    s_nop 0
    v_mfma_f32_16x16x32_bf16 v[54:57], v[26:29], v[92:95], v[54:57]
    v_and_b32_dpp v22, v44, v6 row_newbcast:0 row_mask:0xf bank_mask:0xf
    v_and_b32_dpp v23, v44, v7 row_newbcast:0 row_mask:0xf bank_mask:0xf
    v_and_b32_dpp v24, v44, v8 row_newbcast:0 row_mask:0xf bank_mask:0xf
    v_and_b32_dpp v25, v44, v9 row_newbcast:0 row_mask:0xf bank_mask:0xf
    s_waitcnt vmcnt(7)
    s_nop 0
    v_mfma_f32_16x16x32_bf16 v[54:57], v[22:25], v[96:99], v[54:57]
    v_and_b32_dpp v26, v44, v6 row_newbcast:4 row_mask:0xf bank_mask:0xf
    v_and_b32_dpp v27, v44, v7 row_newbcast:4 row_mask:0xf bank_mask:0xf
    v_and_b32_dpp v28, v44, v8 row_newbcast:4 row_mask:0xf bank_mask:0xf
    v_and_b32_dpp v29, v44, v9 row_newbcast:4 row_mask:0xf bank_mask:0xf
    s_waitcnt vmcnt(6)
    s_nop 0
    v_mfma_f32_16x16x32_bf16 v[54:57], v[26:29], v[100:103], v[54:57]
    v_and_b32_dpp v22, v44, v6 row_newbcast:8 row_mask:0xf bank_mask:0xf
    v_and_b32_dpp v23, v44, v7 row_newbcast:8 row_mask:0xf bank_mask:0xf
    v_and_b32_dpp v24, v44, v8 row_newbcast:8 row_mask:0xf bank_mask:0xf
    v_and_b32_dpp v25, v44, v9 row_newbcast:8 row_mask:0xf bank_mask:0xf
    s_waitcnt vmcnt(5)
    s_nop 0
    v_mfma_f32_16x16x32_bf16 v[54:57], v[22:25], v[104:107], v[54:57]
    v_and_b32_dpp v26, v44, v6 row_newbcast:12 row_mask:0xf bank_mask:0xf
    v_and_b32_dpp v27, v44, v7 row_newbcast:12 row_mask:0xf bank_mask:0xf
    v_and_b32_dpp v28, v44, v8 row_newbcast:12 row_mask:0xf bank_mask:0xf
    v_and_b32_dpp v29, v44, v9 row_newbcast:12 row_mask:0xf bank_mask:0xf
    s_waitcnt vmcnt(4)
    s_nop 0
    v_mfma_f32_16x16x32_bf16 v[54:57], v[26:29], v[108:111], v[54:57]
    v_and_b32_dpp v22, v45, v6 row_newbcast:0 row_mask:0xf bank_mask:0xf
    v_and_b32_dpp v23, v45, v7 row_newbcast:0 row_mask:0xf bank_mask:0xf
    v_and_b32_dpp v24, v45, v8 row_newbcast:0 row_mask:0xf bank_mask:0xf
    v_and_b32_dpp v25, v45, v9 row_newbcast:0 row_mask:0xf bank_mask:0xf
    s_waitcnt vmcnt(3)
    s_nop 0
    v_mfma_f32_16x16x32_bf16 v[54:57], v[22:25], v[112:115], v[54:57]
    v_and_b32_dpp v26, v45, v6 row_newbcast:4 row_mask:0xf bank_mask:0xf
    v_and_b32_dpp v27, v45, v7 row_newbcast:4 row_mask:0xf bank_mask:0xf
    v_and_b32_dpp v28, v45, v8 row_newbcast:4 row_mask:0xf bank_mask:0xf
    v_and_b32_dpp v29, v45, v9 row_newbcast:4 row_mask:0xf bank_mask:0xf
    s_waitcnt vmcnt(2)
    s_nop 0
    v_mfma_f32_16x16x32_bf16 v[54:57], v[26:29], v[116:119], v[54:57]
    v_and_b32_dpp v22, v45, v6 row_newbcast:8 row_mask:0xf bank_mask:0xf
    v_and_b32_dpp v23, v45, v7 row_newbcast:8 row_mask:0xf bank_mask:0xf
    v_and_b32_dpp v24, v45, v8 row_newbcast:8 row_mask:0xf bank_mask:0xf
    v_and_b32_dpp v25, v45, v9 row_newbcast:8 row_mask:0xf bank_mask:0xf
    s_waitcnt vmcnt(1)
    s_nop 0
    v_mfma_f32_16x16x32_bf16 v[54:57], v[22:25], v[120:123], v[54:57]
    v_and_b32_dpp v26, v45, v6 row_newbcast:12 row_mask:0xf bank_mask:0xf
    v_and_b32_dpp v27, v45, v7 row_newbcast:12 row_mask:0xf bank_mask:0xf
    v_and_b32_dpp v28, v45, v8 row_newbcast:12 row_mask:0xf bank_mask:0xf
    v_and_b32_dpp v29, v45, v9 row_newbcast:12 row_mask:0xf bank_mask:0xf
    s_waitcnt vmcnt(0)
    s_nop 0
    v_mfma_f32_16x16x32_bf16 v[54:57], v[26:29], v[124:127], v[54:57]
    v_lshlrev_b32 v13, 6, v4
    v_lshl_or_b32 v13, v5, 5, v13
    v_mov_b32 v14, 0x40000000
    v_cmp_gt_u32 vcc, 32, v0
    s_lshl_b32 s53, s2, 12
    s_lshl_b32 s54, s50, 10
    s_add_u32 s53, s53, s54
    s_add_u32 s53, s53, 0x200000
    v_cndmask_b32 v13, v14, v13, vcc
    s_nop 7
    v_mov_b32 v34, v54
    v_mov_b32 v35, s55
    v_mov_b32 v36, v55
    v_mov_b32 v37, s55
    v_mov_b32 v38, v56
    v_mov_b32 v39, s55
    v_mov_b32 v40, v57
    v_mov_b32 v41, s55
    buffer_store_dwordx4 v[34:37], v13, s[12:15], s53 offen sc1
    buffer_store_dwordx4 v[38:41], v13, s[12:15], s53 offen offset:16 sc1
    s_cmp_lg_u32 s50, 0
    s_cbranch_scc1 END
    v_and_b32 v13, 7, v0
    v_lshlrev_b32 v13, 4, v13
    v_lshrrev_b32 v14, 3, v0
    v_lshl_or_b32 v13, v14, 12, v13
    s_lshl_b32 s53, s2, 7
    s_add_u32 s53, s53, 0x200000
B_YPOLL:
    s_mov_b32 s54, s53
    buffer_load_dwordx4 v[44:47], v13, s[12:15], s54 offen sc1
    s_add_u32 s54, s54, 0x8000
    buffer_load_dwordx4 v[48:51], v13, s[12:15], s54 offen sc1
    s_add_u32 s54, s54, 0x8000
    buffer_load_dwordx4 v[52:55], v13, s[12:15], s54 offen sc1
    s_add_u32 s54, s54, 0x8000
    buffer_load_dwordx4 v[56:59], v13, s[12:15], s54 offen sc1
    s_waitcnt vmcnt(0)
    v_min_u32 v15, v45, v47
    v_max_u32 v16, v45, v47
    v_min3_u32 v15, v15, v49, v51
    v_max3_u32 v16, v16, v49, v51
    v_min3_u32 v15, v15, v53, v55
    v_max3_u32 v16, v16, v53, v55
    v_min3_u32 v15, v15, v57, v59
    v_max3_u32 v16, v16, v57, v59
    v_cmp_ne_u32 vcc, s55, v15
    v_cmp_ne_u32 s[78:79], s55, v16
    s_or_b64 vcc, vcc, s[78:79]
    s_cbranch_vccz B_YDONE
    s_add_u32 s76, s76, 1
    s_and_b32 s78, s76, 63
    s_cmp_lg_u32 s78, 63
    s_cbranch_scc1 SPINR8
    s_waitcnt vmcnt(0)
    buffer_inv sc1
    s_waitcnt vmcnt(0)
SPINR8:
    s_cmp_gt_u32 s76, 0x40000
    s_cbranch_scc1 B_YDONE
    s_sleep 4
    s_branch B_YPOLL
B_YDONE:
    v_add_f32 v44, v44, v48
    v_add_f32 v44, v44, v52
    v_add_f32 v44, v44, v56
    v_add_f32 v46, v46, v50
    v_add_f32 v46, v46, v54
    v_add_f32 v46, v46, v58
    s_nop 1
    v_add_f32_dpp v44, v44, v44 row_ror:8 row_mask:0xf bank_mask:0xf
    s_nop 1
    v_add_f32_dpp v46, v46, v46 row_ror:8 row_mask:0xf bank_mask:0xf
    v_mov_b32 v15, v44
    v_mov_b32 v16, v44
    s_nop 1
    v_permlane16_swap_b32 v15, v16
    s_nop 0
    v_add_f32 v44, v15, v16
    v_mov_b32 v15, v44
    v_mov_b32 v16, v44
    s_nop 1
    v_permlane32_swap_b32 v15, v16
    s_nop 0
    v_add_f32 v44, v15, v16
    v_mov_b32 v15, v46
    v_mov_b32 v16, v46
    s_nop 1
    v_permlane16_swap_b32 v15, v16
    s_nop 0
    v_add_f32 v46, v15, v16
    v_mov_b32 v15, v46
    v_mov_b32 v16, v46
    s_nop 1
    v_permlane32_swap_b32 v15, v16
    s_nop 0
    v_add_f32 v46, v15, v16
    v_cvt_pk_bf16_f32 v44, v44, v46
    s_mov_b32 s16, s44
    s_mov_b32 s17, s45
    s_mov_b32 s18, 0x800
    s_mov_b32 s19, 0x00020000
    v_mov_b32 v16, 0x40000000
    v_cmp_gt_u32 vcc, 8, v0
    v_lshlrev_b32 v15, 2, v0
    s_lshl_b32 s53, s2, 5
    s_add_u32 s53, s53, 1024
    v_cndmask_b32 v15, v16, v15, vcc
    buffer_store_dword v44, v15, s[16:19], s53 offen
    s_cmp_lg_u32 s2, 0
    s_cbranch_scc1 END
    v_mov_b32 v16, s55
    buffer_store_dword v16, v3, s[20:23], 0 offen offset:4 sc1
END:
    s_endpgm
.section .rodata,"a"
.p2align 6
.amdhsa_kernel concat_heads__mha_block_cached__sliding_block_cached__decode_kernel
  .amdhsa_next_free_vgpr 128
  .amdhsa_next_free_sgpr 102
  .amdhsa_accum_offset 128
  .amdhsa_group_segment_fixed_size 0
  .amdhsa_kernarg_size 104
  .amdhsa_user_sgpr_count 2
  .amdhsa_user_sgpr_kernarg_segment_ptr 1
  .amdhsa_system_sgpr_workgroup_id_x 1
.end_amdhsa_kernel
```
